```python
import torch

def _softmax(x, axis=-1):
    return torch.softmax(x, dim=axis)
def _gelu(x):
    return torch.nn.functional.gelu(x, approximate="tanh")
def _silu(x):
    return torch.nn.functional.silu(x)
def _sigmoid(x):
    return torch.sigmoid(x)
def _layernorm(x, axis=-1, eps=1e-5):
    m = x.mean(dim=axis, keepdim=True)
    v = x.var(dim=axis, keepdim=True, unbiased=False)
    return (x - m) / torch.sqrt(v + eps)
def _scatter_add(tgt, idx, src, axis=0):
    return tgt.clone().index_add_(axis, idx, src)
def _segment_sum(src, seg, n):
    out = torch.zeros((n,) + src.shape[1:], dtype=src.dtype)
    return out.index_add_(0, seg, src)
def _pad(x, pw):
    flat = tuple(v for pair in reversed(pw) for v in pair)
    return torch.nn.functional.pad(x, flat)

kernel_name = 'concat_heads__ssm_conv_s4d__grouped_kv_mqa__prompt'

def setup_inputs():

    _w = (lambda a: (lambda t: t.to(torch.bfloat16) if t.is_floating_point() else t)(torch.as_tensor(a)))
    def _A_setup():
        Bsz, L, D, N = 1, 2048, 448, 256
        return {
            "u": _w((lambda *s: torch.randn(*s, dtype=torch.bfloat16) * 0.05)(Bsz, L, D)),
            "log_A_real": _w((lambda *s: torch.randn(*s, dtype=torch.bfloat16) * 6.4)(D, N) * 0.5),
            "A_imag": _w((lambda *s: torch.randn(*s, dtype=torch.bfloat16) * 0.05)(D, N) * 3.14),
            "C_real": _w((lambda *s: torch.randn(*s, dtype=torch.bfloat16) * 0.4)(D, N) / N ** 0.5),
            "C_imag": _w((lambda *s: torch.randn(*s, dtype=torch.bfloat16) * 0.4)(D, N) / N ** 0.5),
            "log_dt": _w((lambda *s: torch.randn(*s, dtype=torch.bfloat16) * 0.05)(D) * 0.5 - 4.0),
            "D_skip": _w((lambda *s: torch.randn(*s, dtype=torch.bfloat16) * 0.05)(D)),
        }
    _A_in = _A_setup()

    def _B_setup():
        B, S, D, H = 1, 2048, 448, 16
        Dh = D // H
        return {
            "x": _w((lambda *s: torch.randn(*s, dtype=torch.bfloat16) * 0.05)(B, S, D)),
            "wq": _w((lambda *s: torch.randn(*s, dtype=torch.bfloat16) * 1.6)(D, H * Dh)),
            "wk": _w((lambda *s: torch.randn(*s, dtype=torch.bfloat16) * 1.6)(D, Dh)),
            "wv": _w((lambda *s: torch.randn(*s, dtype=torch.bfloat16) * 0.05)(D, Dh)),
            "wo": _w((lambda *s: torch.randn(*s, dtype=torch.bfloat16) * 0.05)(H * Dh, D)),
        }
    _B_in = _B_setup()

    return {
        "A_u": _A_in["u"],
        "A_log_A_real": _A_in["log_A_real"],
        "A_A_imag": _A_in["A_imag"],
        "A_C_real": _A_in["C_real"],
        "A_C_imag": _A_in["C_imag"],
        "A_log_dt": _A_in["log_dt"],
        "A_D_skip": _A_in["D_skip"],
        "B_x": _B_in["x"],
        "B_wq": _B_in["wq"],
        "B_wk": _B_in["wk"],
        "B_wv": _B_in["wv"],
        "B_wo": _B_in["wo"],
    }

def reference(A_u, A_log_A_real, A_A_imag, A_C_real, A_C_imag, A_log_dt, A_D_skip, B_x, B_wq, B_wk, B_wv, B_wo):
    def _A_ref(u, log_A_real, A_imag, C_real, C_imag, log_dt, D_skip):
        L = u.shape[1]
        dt = torch.exp(log_dt)
        A = -torch.exp(log_A_real) + 1j * A_imag
        C = (C_real + 1j * C_imag) * dt[:, None]
        pos = (lambda x, dt: x.to(dt))(torch.arange(L), log_dt.dtype)
        P = torch.exp((A * dt[:, None])[:, :, None] * pos[None, None, :])
        K = 2.0 * torch.einsum("dn,dnl->dl", C, P).real
        L2 = 2 * L
        u_t = (lambda x, *d: x.permute(*d))(u, 0, 2, 1)
        Kf = (lambda x, *a, **k: torch.fft.rfft(x.float(), *a, **k))(K, L2)
        Uf = (lambda x, *a, **k: torch.fft.rfft(x.float(), *a, **k))(u_t, L2)
        y = (lambda x, *a, **k: torch.fft.irfft(x, *a, **k).to(torch.bfloat16))(Uf * Kf[None, :, :], L2)[:, :, :L]
        y = (lambda x, *d: x.permute(*d))(y, 0, 2, 1)
        return y + u * D_skip[None, None, :]

    def _B_ref(x, wq, wk, wv, wo):
        B, S, D = x.shape
        H = 16
        Dh = D // H
        q = (lambda x, *d: x.permute(*d))((x @ wq).reshape(B, S, H, Dh), 0, 2, 1, 3)
        k = x @ wk
        v = x @ wv
        scores = torch.einsum("bhqd,bkd->bhqk", q, k) * (Dh ** -0.5)
        p = _softmax(scores, axis=-1)
        o = torch.einsum("bhqk,bkd->bhqd", p, v)
        return (lambda x, *d: x.permute(*d))(o, 0, 2, 1, 3).reshape(B, S, H * Dh) @ wo

    a = _A_ref(A_u, A_log_A_real, A_A_imag, A_C_real, A_C_imag, A_log_dt, A_D_skip)
    b = _B_ref(B_x, B_wq, B_wk, B_wv, B_wo)
    return torch.concatenate([a, b], axis=-1)
```

```asm
; @launch grid=(256,1,1) block=(768,1,1) lds=161344
.amdgcn_target "amdgcn-amd-amdhsa--gfx950"
.text
.globl concat_heads__ssm_conv_s4d__grouped_kv_mqa__prompt_kernel
.p2align 8
.type concat_heads__ssm_conv_s4d__grouped_kv_mqa__prompt_kernel,@function
concat_heads__ssm_conv_s4d__grouped_kv_mqa__prompt_kernel:
    s_cmp_ge_u32 s2, 256
    s_cbranch_scc1 F_end
    s_load_dwordx16 s[16:31], s[0:1], 0
    s_load_dwordx8 s[32:39], s[0:1], 64
    s_load_dwordx2 s[40:41], s[0:1], 96
    s_load_dwordx2 s[42:43], s[0:1], 112
    v_lshrrev_b32 v1, 6, v0
    v_and_b32 v2, 63, v0
    v_readfirstlane_b32 s3, v1
    v_lshlrev_b32 v3, 4, v2
    s_and_b32 s7, s2, 7
    s_lshr_b32 s9, s2, 3
    s_lshr_b32 s5, s2, 5
    s_lshl_b32 s5, s5, 3
    s_or_b32 s44, s7, s5
    s_and_b32 s45, s9, 3
    s_lshl_b32 s8, s7, 5
    s_add_u32 s8, s8, s9
    s_cmp_ge_u32 s3, 8
    s_cbranch_scc1 F_P
F_A:
    s_setprio 1
    s_mov_b32 s63, s3
    s_lshr_b32 s5, s63, 2
    s_and_b32 s6, s63, 3
    v_mov_b32 v127, 161280
    v_mov_b32 v128, 1
    s_cmp_lg_u32 s63, 0
    s_cbranch_scc1 A_noinit
    v_mov_b32 v12, 0
    v_mov_b32 v13, 0
    v_mov_b32 v14, 0
    v_mov_b32 v15, 0
    ds_write_b128 v127, v[12:15] offset:0
    ds_write_b128 v127, v[12:15] offset:16
    ds_write_b128 v127, v[12:15] offset:32
    ds_write_b128 v127, v[12:15] offset:48
A_noinit:
    s_cmp_eq_u32 s7, 7
    s_cbranch_scc1 A_nokg
    s_lshl_b32 s4, s8, 1
    s_add_u32 s4, s4, s5
    s_lshl_b32 s10, s4, 9
    s_lshl_b32 s11, s6, 7
    s_add_u32 s10, s10, s11
    v_lshl_add_u32 v11, v2, 1, s10
    s_lshl_b32 s10, s8, 2
    s_waitcnt lgkmcnt(0)
    global_load_ushort v4, v11, s[18:19] nt
    global_load_ushort v5, v11, s[20:21] nt
    global_load_ushort v6, v11, s[22:23] nt
    global_load_ushort v7, v11, s[24:25] nt
    s_load_dword s11, s[26:27], s10
    s_load_dword s12, s[28:29], s10
    s_barrier
    s_add_u32 s48, s42, 0xc20000
    s_addc_u32 s49, s43, 0
    s_load_dword s46, s[48:49], 0
    s_mov_b32 s50, 0x40000
    s_mov_b32 s51, 0x20000
    s_add_u32 s52, s42, 0x200000
    s_addc_u32 s53, s43, 0
    s_mov_b32 s54, 0x40000
    s_mov_b32 s55, 0x20000
    s_lshl_b32 s13, s6, 6
    v_add_u32 v8, s13, v2
    s_mov_b32 s28, s32
    s_mov_b32 s29, s33
    s_mov_b32 s30, 0x62000
    s_mov_b32 s31, 0x20000
    s_mul_i32 s14, s5, 34816
    s_add_u32 s32, s14, 3072
    s_mul_i32 s33, s63, 8704
    v_mov_b32 v100, v8
    s_movk_i32 s35, 1024
    v_and_b32 v9, 31, v2
    v_lshrrev_b32 v10, 5, v2
    v_mul_u32_u24 v116, 272, v9
    v_lshl_add_u32 v116, v10, 4, v116
    v_add_u32 v116, s33, v116
    s_mov_b32 m0, s33
    s_mul_i32 s34, s5, 21248
    s_add_u32 s34, s34, 98304
    v_lshlrev_b32 v101, 4, v100
    v_sub_u32 v101, 4094, v101
    v_cvt_f32_i32 v129, v101
    v_add_f32 v130, 0xc0000000, v129
    v_add_f32 v131, 0xc0800000, v129
    v_add_f32 v132, 0xc0c00000, v129
    v_add_f32 v133, 0xc1000000, v129
    v_add_f32 v134, 0xc1200000, v129
    v_add_f32 v135, 0xc1400000, v129
    v_add_f32 v136, 0xc1600000, v129
    v_add_f32 v137, 0xc1800000, v129
    v_add_f32 v138, 0xc1900000, v129
    v_add_f32 v139, 0xc1a00000, v129
    v_cvt_pk_bf16_f32 v102, v129, v130
    v_lshlrev_b32 v129, 16, v102
    v_and_b32 v130, 0xffff0000, v102
    v_cvt_pk_bf16_f32 v102, v131, v132
    v_lshlrev_b32 v131, 16, v102
    v_and_b32 v132, 0xffff0000, v102
    v_cvt_pk_bf16_f32 v102, v133, v134
    v_lshlrev_b32 v133, 16, v102
    v_and_b32 v134, 0xffff0000, v102
    v_cvt_pk_bf16_f32 v102, v135, v136
    v_lshlrev_b32 v135, 16, v102
    v_and_b32 v136, 0xffff0000, v102
    v_cvt_pk_bf16_f32 v102, v137, v138
    v_lshlrev_b32 v137, 16, v102
    v_and_b32 v138, 0xffff0000, v102
    v_cvt_pk_bf16_f32 v102, v139, v139
    v_lshlrev_b32 v139, 16, v102
    v_cvt_u32_f32 v129, v129
    v_cvt_u32_f32 v130, v130
    v_cvt_u32_f32 v131, v131
    v_cvt_u32_f32 v132, v132
    v_cvt_u32_f32 v133, v133
    v_cvt_u32_f32 v134, v134
    v_cvt_u32_f32 v135, v135
    v_cvt_u32_f32 v136, v136
    v_cvt_u32_f32 v137, v137
    v_cvt_u32_f32 v138, v138
    v_cvt_u32_f32 v139, v139
    v_mov_b32 v102, 4128
    v_cmp_eq_u32 vcc, 255, v100
    v_lshrrev_b32 v101, 5, v100
    v_and_b32 v103, 31, v100
    v_cndmask_b32 v137, v137, v102, vcc
    v_cndmask_b32 v138, v138, v102, vcc
    v_cndmask_b32 v139, v139, v102, vcc
    v_lshrrev_b32 v104, 4, v129
    v_lshl_add_u32 v104, v104, 2, s32
    v_add_u32 v129, v104, v129
    v_lshrrev_b32 v104, 4, v130
    v_lshl_add_u32 v104, v104, 2, s32
    v_add_u32 v130, v104, v130
    v_lshrrev_b32 v104, 4, v131
    v_lshl_add_u32 v104, v104, 2, s32
    v_add_u32 v131, v104, v131
    v_lshrrev_b32 v104, 4, v132
    v_lshl_add_u32 v104, v104, 2, s32
    v_add_u32 v132, v104, v132
    v_lshrrev_b32 v104, 4, v133
    v_lshl_add_u32 v104, v104, 2, s32
    v_add_u32 v133, v104, v133
    v_lshrrev_b32 v104, 4, v134
    v_lshl_add_u32 v104, v104, 2, s32
    v_add_u32 v134, v104, v134
    v_lshrrev_b32 v104, 4, v135
    v_lshl_add_u32 v104, v104, 2, s32
    v_add_u32 v135, v104, v135
    v_lshrrev_b32 v104, 4, v136
    v_lshl_add_u32 v104, v104, 2, s32
    v_add_u32 v136, v104, v136
    v_lshrrev_b32 v104, 4, v137
    v_lshl_add_u32 v104, v104, 2, s32
    v_add_u32 v137, v104, v137
    v_lshrrev_b32 v104, 4, v138
    v_lshl_add_u32 v104, v104, 2, s32
    v_add_u32 v138, v104, v138
    v_lshrrev_b32 v104, 4, v139
    v_lshl_add_u32 v104, v104, 2, s32
    v_add_u32 v139, v104, v139
    v_lshlrev_b32 v103, 3, v103
    v_add_u32 v110, v101, v103
    v_lshlrev_b32 v102, 1, v101
    v_add_u32 v102, 256, v102
    v_lshrrev_b32 v104, 1, v101
    v_lshlrev_b32 v104, 8, v104
    v_and_b32 v105, 1, v101
    v_cmp_gt_u32 vcc, 4, v101
    v_lshl_add_u32 v104, v105, 2, v104
    v_lshlrev_b32 v112, 8, v101
    v_cndmask_b32 v111, v104, v102, vcc
    v_add_u32 v111, v111, v103
    v_add3_u32 v112, v112, v103, s35
    v_min_u32 v112, 2056, v112
    v_lshrrev_b32 v104, 3, v110
    v_lshl_add_u32 v104, v104, 2, s32
    v_lshl_add_u32 v110, v110, 1, v104
    v_lshrrev_b32 v104, 3, v111
    v_lshl_add_u32 v104, v104, 2, s32
    v_lshl_add_u32 v111, v111, 1, v104
    v_lshrrev_b32 v104, 3, v112
    v_lshl_add_u32 v104, v104, 2, s32
    v_lshl_add_u32 v112, v112, 1, v104
    v_and_b32 v113, 3, v101
    v_lshlrev_b32 v113, 8, v113
    v_lshrrev_b32 v102, 2, v101
    v_lshl_add_u32 v113, v102, 7, v113
    v_lshrrev_b32 v102, 1, v103
    v_add3_u32 v113, v113, v102, s14
    v_mov_b32 v114, s32
    v_lshl_add_u32 v126, v100, 4, s34
    s_lshl_b32 s13, s5, 4
    v_add_u32 v119, s13, v127
    v_lshlrev_b32 v109, 6, v2
    v_and_b32 v109, 0x7ff, v109
    s_lshl_b32 s10, s7, 13
    s_bfe_u32 s13, s9, 0x20003
    s_lshl_b32 s13, s13, 11
    s_add_u32 s10, s10, s13
    s_add_u32 s10, s10, 32768
    v_add_u32 v109, s10, v109
    s_waitcnt lgkmcnt(0)
    s_mul_i32 s46, s46, 0x9E3779B1
    s_add_u32 s46, s46, 0x7F4A7C15
    s_lshl_b32 s13, s5, 4
    s_lshr_b32 s11, s11, s13
    s_lshl_b32 s11, s11, 16
    s_lshr_b32 s12, s12, s13
    s_lshl_b32 s12, s12, 16
    s_mov_b32 s13, 0x3fb8aa3b
    v_mov_b32 v9, s11
    v_mul_f32 v9, s13, v9
    v_exp_f32 v9, v9
    v_mov_b32 v118, s12
    v_cmp_eq_u32 vcc, 0, v8
    v_cvt_pk_bf16_f32 v9, v9, v9
    s_nop 0
    v_cndmask_b32 v118, 0, v118, vcc
    v_lshlrev_b32 v9, 16, v9
    s_waitcnt vmcnt(0)
    s_lshl_b32 s10, s9, 3
    s_add_u32 s10, s10, s63
    s_mul_i32 s10, s10, 1664
    v_lshlrev_b32 v107, 7, v2
    s_mov_b64 exec, 0x1fff
    buffer_load_dword v107, v107, s[28:31], s10 offen
    s_mov_b64 exec, -1
    v_lshlrev_b32 v4, 16, v4
    v_lshlrev_b32 v5, 16, v5
    v_lshlrev_b32 v6, 16, v6
    v_lshlrev_b32 v7, 16, v7
    v_mul_f32 v4, s13, v4
    v_exp_f32 v4, v4
    v_mul_f32 v5, v5, v9
    v_cvt_pk_bf16_f32 v4, v4, v4
    v_mul_f32 v5, 0.15915494, v5
    v_lshlrev_b32 v4, 16, v4
    v_mul_f32 v6, v6, v9
    v_mul_f32 v4, v4, v9
    v_mul_f32 v7, v7, v9
    v_mul_f32 v4, s13, v4
    v_add_f32 v20, v6, v6
    v_mul_f32 v21, -2.0, v7
    v_mul_f32 v25, 0x3f800000, v5
    v_mul_f32 v24, 0xbf800000, v4
    v_mul_f32 v28, 0x41000000, v5
    v_mul_f32 v27, 0xc1000000, v4
    v_mul_f32 v31, 0x43000000, v5
    v_mul_f32 v30, 0xc3000000, v4
    v_mul_f32 v34, 0x43800000, v5
    v_mul_f32 v33, 0xc3800000, v4
    v_fract_f32 v25, v25
    v_fract_f32 v28, v28
    v_fract_f32 v31, v31
    v_fract_f32 v34, v34
    v_exp_f32 v24, v24
    v_cos_f32 v10, v25
    v_sin_f32 v11, v25
    v_exp_f32 v27, v27
    v_cos_f32 v12, v28
    v_sin_f32 v13, v28
    v_exp_f32 v30, v30
    v_cos_f32 v14, v31
    v_sin_f32 v15, v31
    v_exp_f32 v33, v33
    v_cos_f32 v16, v34
    v_sin_f32 v17, v34
    v_mul_f32 v10, v10, v24
    v_mul_f32 v11, v11, v24
    v_mul_f32 v12, v12, v27
    v_mul_f32 v13, v13, v27
    v_mul_f32 v14, v14, v30
    v_mul_f32 v15, v15, v30
    v_mul_f32 v16, v16, v33
    v_mul_f32 v17, v17, v33
    v_mov_b32 v40, 0x3f80
    v_cvt_pk_bf16_f32 v41, v12, v13
    v_cvt_pk_bf16_f32 v56, v14, v15
    v_cvt_pk_bf16_f32 v72, v20, v21
    v_pk_mul_f32 v[4:5], v[14:15], v[12:13] op_sel_hi:[1,0]
    v_pk_mul_f32 v[8:9], v[12:13], v[12:13] op_sel_hi:[1,0]
    v_pk_mul_f32 v[36:37], v[10:11], v[10:11] op_sel_hi:[1,0]
    v_pk_mul_f32 v[0:1], v[20:21], v[10:11] op_sel_hi:[1,0]
    v_pk_fma_f32 v[28:29], v[14:15], v[12:13], v[4:5] op_sel:[1,1,0] op_sel_hi:[0,1,1] neg_lo:[1,0,0]
    v_pk_fma_f32 v[24:25], v[12:13], v[12:13], v[8:9] op_sel:[1,1,0] op_sel_hi:[0,1,1] neg_lo:[1,0,0]
    v_pk_fma_f32 v[18:19], v[10:11], v[10:11], v[36:37] op_sel:[1,1,0] op_sel_hi:[0,1,1] neg_lo:[1,0,0]
    v_pk_fma_f32 v[32:33], v[20:21], v[10:11], v[0:1] op_sel:[1,1,0] op_sel_hi:[0,1,1] neg_hi:[1,0,0]
    v_cvt_pk_bf16_f32 v57, v28, v29
    v_cvt_pk_bf16_f32 v42, v24, v25
    v_cvt_pk_bf16_f32 v73, v32, v33
    v_pk_mul_f32 v[4:5], v[28:29], v[12:13] op_sel_hi:[1,0]
    v_pk_mul_f32 v[8:9], v[24:25], v[12:13] op_sel_hi:[1,0]
    v_pk_mul_f32 v[36:37], v[18:19], v[18:19] op_sel_hi:[1,0]
    v_pk_mul_f32 v[0:1], v[32:33], v[10:11] op_sel_hi:[1,0]
    v_pk_fma_f32 v[30:31], v[28:29], v[12:13], v[4:5] op_sel:[1,1,0] op_sel_hi:[0,1,1] neg_lo:[1,0,0]
    v_pk_fma_f32 v[26:27], v[24:25], v[12:13], v[8:9] op_sel:[1,1,0] op_sel_hi:[0,1,1] neg_lo:[1,0,0]
    v_pk_fma_f32 v[94:95], v[18:19], v[18:19], v[36:37] op_sel:[1,1,0] op_sel_hi:[0,1,1] neg_lo:[1,0,0]
    v_pk_fma_f32 v[34:35], v[32:33], v[10:11], v[0:1] op_sel:[1,1,0] op_sel_hi:[0,1,1] neg_hi:[1,0,0]
    v_cvt_pk_bf16_f32 v58, v30, v31
    v_cvt_pk_bf16_f32 v43, v26, v27
    v_cvt_pk_bf16_f32 v74, v34, v35
    v_pk_mul_f32 v[4:5], v[30:31], v[12:13] op_sel_hi:[1,0]
    v_pk_mul_f32 v[8:9], v[26:27], v[12:13] op_sel_hi:[1,0]
    v_pk_mul_f32 v[36:37], v[20:21], v[16:17] op_sel_hi:[1,0]
    v_pk_mul_f32 v[0:1], v[34:35], v[10:11] op_sel_hi:[1,0]
    v_pk_fma_f32 v[28:29], v[30:31], v[12:13], v[4:5] op_sel:[1,1,0] op_sel_hi:[0,1,1] neg_lo:[1,0,0]
    v_pk_fma_f32 v[24:25], v[26:27], v[12:13], v[8:9] op_sel:[1,1,0] op_sel_hi:[0,1,1] neg_lo:[1,0,0]
    v_pk_fma_f32 v[96:97], v[20:21], v[16:17], v[36:37] op_sel:[1,1,0] op_sel_hi:[0,1,1] neg_hi:[1,0,0]
    v_pk_fma_f32 v[32:33], v[34:35], v[10:11], v[0:1] op_sel:[1,1,0] op_sel_hi:[0,1,1] neg_hi:[1,0,0]
    v_cvt_pk_bf16_f32 v59, v28, v29
    v_cvt_pk_bf16_f32 v44, v24, v25
    v_cvt_pk_bf16_f32 v80, v96, v97
    v_cvt_pk_bf16_f32 v75, v32, v33
    v_pk_mul_f32 v[4:5], v[28:29], v[12:13] op_sel_hi:[1,0]
    v_pk_mul_f32 v[8:9], v[24:25], v[12:13] op_sel_hi:[1,0]
    v_pk_mul_f32 v[36:37], v[96:97], v[16:17] op_sel_hi:[1,0]
    v_pk_mul_f32 v[0:1], v[32:33], v[10:11] op_sel_hi:[1,0]
    v_pk_fma_f32 v[30:31], v[28:29], v[12:13], v[4:5] op_sel:[1,1,0] op_sel_hi:[0,1,1] neg_lo:[1,0,0]
    v_pk_fma_f32 v[26:27], v[24:25], v[12:13], v[8:9] op_sel:[1,1,0] op_sel_hi:[0,1,1] neg_lo:[1,0,0]
    v_pk_fma_f32 v[98:99], v[96:97], v[16:17], v[36:37] op_sel:[1,1,0] op_sel_hi:[0,1,1] neg_hi:[1,0,0]
    v_pk_fma_f32 v[34:35], v[32:33], v[10:11], v[0:1] op_sel:[1,1,0] op_sel_hi:[0,1,1] neg_hi:[1,0,0]
    v_cvt_pk_bf16_f32 v60, v30, v31
    v_cvt_pk_bf16_f32 v45, v26, v27
    v_cvt_pk_bf16_f32 v84, v98, v99
    v_cvt_pk_bf16_f32 v76, v34, v35
    v_pk_mul_f32 v[4:5], v[30:31], v[12:13] op_sel_hi:[1,0]
    v_pk_mul_f32 v[8:9], v[26:27], v[12:13] op_sel_hi:[1,0]
    v_pk_mul_f32 v[36:37], v[98:99], v[16:17] op_sel_hi:[1,0]
    v_pk_mul_f32 v[0:1], v[34:35], v[10:11] op_sel_hi:[1,0]
    v_pk_fma_f32 v[28:29], v[30:31], v[12:13], v[4:5] op_sel:[1,1,0] op_sel_hi:[0,1,1] neg_lo:[1,0,0]
    v_pk_fma_f32 v[24:25], v[26:27], v[12:13], v[8:9] op_sel:[1,1,0] op_sel_hi:[0,1,1] neg_lo:[1,0,0]
    v_pk_fma_f32 v[38:39], v[98:99], v[16:17], v[36:37] op_sel:[1,1,0] op_sel_hi:[0,1,1] neg_hi:[1,0,0]
    v_pk_fma_f32 v[32:33], v[34:35], v[10:11], v[0:1] op_sel:[1,1,0] op_sel_hi:[0,1,1] neg_hi:[1,0,0]
    v_cvt_pk_bf16_f32 v61, v28, v29
    v_cvt_pk_bf16_f32 v46, v24, v25
    v_cvt_pk_bf16_f32 v86, v38, v39
    v_cvt_pk_bf16_f32 v77, v32, v33
    v_pk_mul_f32 v[4:5], v[28:29], v[12:13] op_sel_hi:[1,0]
    v_pk_mul_f32 v[8:9], v[24:25], v[12:13] op_sel_hi:[1,0]
    v_pk_mul_f32 v[36:37], v[38:39], v[16:17] op_sel_hi:[1,0]
    v_pk_mul_f32 v[0:1], v[32:33], v[10:11] op_sel_hi:[1,0]
    v_pk_fma_f32 v[30:31], v[28:29], v[12:13], v[4:5] op_sel:[1,1,0] op_sel_hi:[0,1,1] neg_lo:[1,0,0]
    v_pk_fma_f32 v[26:27], v[24:25], v[12:13], v[8:9] op_sel:[1,1,0] op_sel_hi:[0,1,1] neg_lo:[1,0,0]
    v_pk_fma_f32 v[22:23], v[38:39], v[16:17], v[36:37] op_sel:[1,1,0] op_sel_hi:[0,1,1] neg_hi:[1,0,0]
    v_pk_fma_f32 v[34:35], v[32:33], v[10:11], v[0:1] op_sel:[1,1,0] op_sel_hi:[0,1,1] neg_hi:[1,0,0]
    v_cvt_pk_bf16_f32 v62, v30, v31
    v_cvt_pk_bf16_f32 v47, v26, v27
    v_cvt_pk_bf16_f32 v88, v22, v23
    v_cvt_pk_bf16_f32 v78, v34, v35
    v_pk_mul_f32 v[4:5], v[30:31], v[12:13] op_sel_hi:[1,0]
    v_pk_mul_f32 v[8:9], v[26:27], v[12:13] op_sel_hi:[1,0]
    v_pk_mul_f32 v[36:37], v[22:23], v[16:17] op_sel_hi:[1,0]
    v_pk_mul_f32 v[0:1], v[34:35], v[10:11] op_sel_hi:[1,0]
    v_pk_fma_f32 v[28:29], v[30:31], v[12:13], v[4:5] op_sel:[1,1,0] op_sel_hi:[0,1,1] neg_lo:[1,0,0]
    v_pk_fma_f32 v[24:25], v[26:27], v[12:13], v[8:9] op_sel:[1,1,0] op_sel_hi:[0,1,1] neg_lo:[1,0,0]
    v_pk_fma_f32 v[6:7], v[22:23], v[16:17], v[36:37] op_sel:[1,1,0] op_sel_hi:[0,1,1] neg_hi:[1,0,0]
    v_pk_fma_f32 v[32:33], v[34:35], v[10:11], v[0:1] op_sel:[1,1,0] op_sel_hi:[0,1,1] neg_hi:[1,0,0]
    v_cvt_pk_bf16_f32 v63, v28, v29
    v_cvt_pk_bf16_f32 v48, v24, v25
    v_cvt_pk_bf16_f32 v89, v6, v7
    v_cvt_pk_bf16_f32 v79, v32, v33
    v_pk_mul_f32 v[4:5], v[28:29], v[12:13] op_sel_hi:[1,0]
    v_pk_mul_f32 v[8:9], v[24:25], v[12:13] op_sel_hi:[1,0]
    v_pk_mul_f32 v[36:37], v[6:7], v[16:17] op_sel_hi:[1,0]
    v_pk_mul_f32 v[0:1], v[96:97], v[18:19] op_sel_hi:[1,0]
    v_pk_fma_f32 v[30:31], v[28:29], v[12:13], v[4:5] op_sel:[1,1,0] op_sel_hi:[0,1,1] neg_lo:[1,0,0]
    v_pk_fma_f32 v[26:27], v[24:25], v[12:13], v[8:9] op_sel:[1,1,0] op_sel_hi:[0,1,1] neg_lo:[1,0,0]
    v_pk_fma_f32 v[22:23], v[6:7], v[16:17], v[36:37] op_sel:[1,1,0] op_sel_hi:[0,1,1] neg_hi:[1,0,0]
    v_pk_fma_f32 v[32:33], v[96:97], v[18:19], v[0:1] op_sel:[1,1,0] op_sel_hi:[0,1,1] neg_hi:[1,0,0]
    v_cvt_pk_bf16_f32 v64, v30, v31
    v_cvt_pk_bf16_f32 v49, v26, v27
    v_cvt_pk_bf16_f32 v90, v22, v23
    v_cvt_pk_bf16_f32 v81, v32, v33
    v_pk_mul_f32 v[4:5], v[30:31], v[12:13] op_sel_hi:[1,0]
    v_pk_mul_f32 v[8:9], v[26:27], v[12:13] op_sel_hi:[1,0]
    v_pk_mul_f32 v[36:37], v[22:23], v[16:17] op_sel_hi:[1,0]
    v_pk_mul_f32 v[0:1], v[32:33], v[18:19] op_sel_hi:[1,0]
    v_pk_fma_f32 v[28:29], v[30:31], v[12:13], v[4:5] op_sel:[1,1,0] op_sel_hi:[0,1,1] neg_lo:[1,0,0]
    v_pk_fma_f32 v[24:25], v[26:27], v[12:13], v[8:9] op_sel:[1,1,0] op_sel_hi:[0,1,1] neg_lo:[1,0,0]
    v_pk_fma_f32 v[6:7], v[22:23], v[16:17], v[36:37] op_sel:[1,1,0] op_sel_hi:[0,1,1] neg_hi:[1,0,0]
    v_pk_fma_f32 v[34:35], v[32:33], v[18:19], v[0:1] op_sel:[1,1,0] op_sel_hi:[0,1,1] neg_hi:[1,0,0]
    v_cvt_pk_bf16_f32 v65, v28, v29
    v_cvt_pk_bf16_f32 v50, v24, v25
    v_cvt_pk_bf16_f32 v91, v6, v7
    v_cvt_pk_bf16_f32 v82, v34, v35
    v_pk_mul_f32 v[4:5], v[28:29], v[12:13] op_sel_hi:[1,0]
    v_pk_mul_f32 v[8:9], v[24:25], v[12:13] op_sel_hi:[1,0]
    v_pk_mul_f32 v[36:37], v[6:7], v[16:17] op_sel_hi:[1,0]
    v_pk_mul_f32 v[0:1], v[34:35], v[18:19] op_sel_hi:[1,0]
    v_pk_fma_f32 v[30:31], v[28:29], v[12:13], v[4:5] op_sel:[1,1,0] op_sel_hi:[0,1,1] neg_lo:[1,0,0]
    v_pk_fma_f32 v[26:27], v[24:25], v[12:13], v[8:9] op_sel:[1,1,0] op_sel_hi:[0,1,1] neg_lo:[1,0,0]
    v_pk_fma_f32 v[22:23], v[6:7], v[16:17], v[36:37] op_sel:[1,1,0] op_sel_hi:[0,1,1] neg_hi:[1,0,0]
    v_pk_fma_f32 v[32:33], v[34:35], v[18:19], v[0:1] op_sel:[1,1,0] op_sel_hi:[0,1,1] neg_hi:[1,0,0]
    v_cvt_pk_bf16_f32 v66, v30, v31
    v_cvt_pk_bf16_f32 v51, v26, v27
    v_cvt_pk_bf16_f32 v92, v22, v23
    v_cvt_pk_bf16_f32 v83, v32, v33
    v_pk_mul_f32 v[4:5], v[30:31], v[12:13] op_sel_hi:[1,0]
    v_pk_mul_f32 v[8:9], v[26:27], v[12:13] op_sel_hi:[1,0]
    v_pk_mul_f32 v[36:37], v[98:99], v[94:95] op_sel_hi:[1,0]
    v_pk_fma_f32 v[28:29], v[30:31], v[12:13], v[4:5] op_sel:[1,1,0] op_sel_hi:[0,1,1] neg_lo:[1,0,0]
    v_pk_fma_f32 v[24:25], v[26:27], v[12:13], v[8:9] op_sel:[1,1,0] op_sel_hi:[0,1,1] neg_lo:[1,0,0]
    v_pk_fma_f32 v[22:23], v[98:99], v[94:95], v[36:37] op_sel:[1,1,0] op_sel_hi:[0,1,1] neg_hi:[1,0,0]
    v_cvt_pk_bf16_f32 v67, v28, v29
    v_cvt_pk_bf16_f32 v52, v24, v25
    v_cvt_pk_bf16_f32 v85, v22, v23
    v_pk_mul_f32 v[4:5], v[28:29], v[12:13] op_sel_hi:[1,0]
    v_pk_mul_f32 v[8:9], v[24:25], v[12:13] op_sel_hi:[1,0]
    v_pk_mul_f32 v[36:37], v[38:39], v[94:95] op_sel_hi:[1,0]
    v_pk_fma_f32 v[30:31], v[28:29], v[12:13], v[4:5] op_sel:[1,1,0] op_sel_hi:[0,1,1] neg_lo:[1,0,0]
    v_pk_fma_f32 v[26:27], v[24:25], v[12:13], v[8:9] op_sel:[1,1,0] op_sel_hi:[0,1,1] neg_lo:[1,0,0]
    v_pk_fma_f32 v[6:7], v[38:39], v[94:95], v[36:37] op_sel:[1,1,0] op_sel_hi:[0,1,1] neg_hi:[1,0,0]
    v_cvt_pk_bf16_f32 v68, v30, v31
    v_cvt_pk_bf16_f32 v53, v26, v27
    v_cvt_pk_bf16_f32 v87, v6, v7
    v_pk_mul_f32 v[4:5], v[30:31], v[12:13] op_sel_hi:[1,0]
    v_pk_mul_f32 v[8:9], v[26:27], v[12:13] op_sel_hi:[1,0]
    v_pk_fma_f32 v[28:29], v[30:31], v[12:13], v[4:5] op_sel:[1,1,0] op_sel_hi:[0,1,1] neg_lo:[1,0,0]
    v_pk_fma_f32 v[24:25], v[26:27], v[12:13], v[8:9] op_sel:[1,1,0] op_sel_hi:[0,1,1] neg_lo:[1,0,0]
    v_cvt_pk_bf16_f32 v69, v28, v29
    v_cvt_pk_bf16_f32 v54, v24, v25
    v_pk_mul_f32 v[4:5], v[28:29], v[12:13] op_sel_hi:[1,0]
    v_pk_mul_f32 v[8:9], v[24:25], v[12:13] op_sel_hi:[1,0]
    v_pk_fma_f32 v[30:31], v[28:29], v[12:13], v[4:5] op_sel:[1,1,0] op_sel_hi:[0,1,1] neg_lo:[1,0,0]
    v_pk_fma_f32 v[26:27], v[24:25], v[12:13], v[8:9] op_sel:[1,1,0] op_sel_hi:[0,1,1] neg_lo:[1,0,0]
    v_cvt_pk_bf16_f32 v70, v30, v31
    v_cvt_pk_bf16_f32 v55, v26, v27
    v_pk_mul_f32 v[4:5], v[30:31], v[12:13] op_sel_hi:[1,0]
    v_pk_fma_f32 v[28:29], v[30:31], v[12:13], v[4:5] op_sel:[1,1,0] op_sel_hi:[0,1,1] neg_lo:[1,0,0]
    v_cvt_pk_bf16_f32 v71, v28, v29
    ds_write_addtid_b32 v40 offset:0
    ds_write_addtid_b32 v41 offset:272
    ds_write_addtid_b32 v42 offset:544
    ds_write_addtid_b32 v43 offset:816
    ds_write_addtid_b32 v44 offset:1088
    ds_write_addtid_b32 v45 offset:1360
    ds_write_addtid_b32 v46 offset:1632
    ds_write_addtid_b32 v47 offset:1904
    ds_write_addtid_b32 v48 offset:2176
    ds_write_addtid_b32 v49 offset:2448
    ds_write_addtid_b32 v50 offset:2720
    ds_write_addtid_b32 v51 offset:2992
    ds_write_addtid_b32 v52 offset:3264
    ds_write_addtid_b32 v53 offset:3536
    ds_write_addtid_b32 v54 offset:3808
    ds_write_addtid_b32 v55 offset:4080
    ds_write_addtid_b32 v56 offset:4352
    ds_write_addtid_b32 v57 offset:4624
    ds_write_addtid_b32 v58 offset:4896
    ds_write_addtid_b32 v59 offset:5168
    ds_write_addtid_b32 v60 offset:5440
    ds_write_addtid_b32 v61 offset:5712
    ds_write_addtid_b32 v62 offset:5984
    ds_write_addtid_b32 v63 offset:6256
    ds_write_addtid_b32 v64 offset:6528
    ds_write_addtid_b32 v65 offset:6800
    ds_write_addtid_b32 v66 offset:7072
    ds_write_addtid_b32 v67 offset:7344
    ds_write_addtid_b32 v68 offset:7616
    ds_write_addtid_b32 v69 offset:7888
    ds_write_addtid_b32 v70 offset:8160
    ds_write_addtid_b32 v71 offset:8432
    ds_read_b128 v[40:43], v116 offset:0
    ds_read_b128 v[44:47], v116 offset:32
    ds_read_b128 v[48:51], v116 offset:64
    ds_read_b128 v[52:55], v116 offset:96
    ds_read_b128 v[56:59], v116 offset:128
    ds_read_b128 v[60:63], v116 offset:160
    ds_read_b128 v[64:67], v116 offset:192
    ds_read_b128 v[68:71], v116 offset:224
    ds_write_addtid_b32 v72 offset:0
    ds_write_addtid_b32 v73 offset:272
    ds_write_addtid_b32 v74 offset:544
    ds_write_addtid_b32 v75 offset:816
    ds_write_addtid_b32 v76 offset:1088
    ds_write_addtid_b32 v77 offset:1360
    ds_write_addtid_b32 v78 offset:1632
    ds_write_addtid_b32 v79 offset:1904
    ds_write_addtid_b32 v80 offset:2176
    ds_write_addtid_b32 v81 offset:2448
    ds_write_addtid_b32 v82 offset:2720
    ds_write_addtid_b32 v83 offset:2992
    ds_write_addtid_b32 v84 offset:3264
    ds_write_addtid_b32 v85 offset:3536
    ds_write_addtid_b32 v86 offset:3808
    ds_write_addtid_b32 v87 offset:4080
    ds_write_addtid_b32 v88 offset:4352
    ds_write_addtid_b32 v89 offset:4624
    ds_write_addtid_b32 v90 offset:4896
    ds_write_addtid_b32 v91 offset:5168
    ds_write_addtid_b32 v92 offset:5440
    ds_read_b128 v[72:75], v116 offset:0
    ds_read_b128 v[76:79], v116 offset:32
    ds_read_b128 v[80:83], v116 offset:64
    ds_read_b128 v[84:87], v116 offset:96
    ds_read_b128 v[88:91], v116 offset:128
    ds_read_b128 v[92:95], v116 offset:160
    ds_read_b128 v[96:99], v116 offset:192
    ds_read_b128 v[8:11], v116 offset:224
    s_waitcnt lgkmcnt(7)
    v_mfma_f32_32x32x16_bf16 v[24:39], v[72:75], v[40:43], 0
    s_waitcnt lgkmcnt(6)
    v_mfma_f32_32x32x16_bf16 v[24:39], v[76:79], v[44:47], v[24:39]
    s_waitcnt lgkmcnt(5)
    v_mfma_f32_32x32x16_bf16 v[24:39], v[80:83], v[48:51], v[24:39]
    s_waitcnt lgkmcnt(4)
    v_mfma_f32_32x32x16_bf16 v[24:39], v[84:87], v[52:55], v[24:39]
    s_waitcnt lgkmcnt(3)
    v_mfma_f32_32x32x16_bf16 v[24:39], v[88:91], v[56:59], v[24:39]
    s_waitcnt lgkmcnt(2)
    v_mfma_f32_32x32x16_bf16 v[24:39], v[92:95], v[60:63], v[24:39]
    s_waitcnt lgkmcnt(1)
    v_mfma_f32_32x32x16_bf16 v[24:39], v[96:99], v[64:67], v[24:39]
    s_waitcnt lgkmcnt(0)
    v_mfma_f32_32x32x16_bf16 v[24:39], v[8:11], v[68:71], v[24:39]
    v_mov_b32 v12, 0
    v_mov_b32 v13, 0
    v_mov_b32 v14, 0
    v_mov_b32 v15, 0
    s_nop 7
    ds_write_addtid_b32 v24 offset:0
    ds_write_addtid_b32 v25 offset:256
    ds_write_addtid_b32 v26 offset:512
    ds_write_addtid_b32 v27 offset:768
    ds_write_addtid_b32 v28 offset:1024
    ds_write_addtid_b32 v29 offset:1280
    ds_write_addtid_b32 v30 offset:1536
    ds_write_addtid_b32 v31 offset:1792
    ds_write_addtid_b32 v32 offset:2048
    ds_write_addtid_b32 v33 offset:2304
    ds_write_addtid_b32 v34 offset:2560
    ds_write_addtid_b32 v35 offset:2816
    s_waitcnt lgkmcnt(0)
    s_mov_b64 exec, 1
    ds_add_u32 v119, v128 offset:8
    s_mov_b64 exec, -1
    s_mov_b32 s47, 0
AS1_spin:
    ds_read_b32 v16, v119 offset:8
    s_add_u32 s47, s47, 1
    s_waitcnt lgkmcnt(0)
    v_readfirstlane_b32 s15, v16
    s_nop 0
    s_cmp_ge_u32 s15, 4
    s_cbranch_scc1 AS1_go
    s_cmp_lt_u32 s47, 2000000
    s_cbranch_scc1 AS1_spin
AS1_go:
    ds_read_b32 v40, v113 offset:0
    ds_read_b32 v41, v113 offset:8704
    ds_read_b32 v42, v113 offset:17408
    ds_read_b32 v43, v113 offset:26112
    ds_read_b32 v44, v113 offset:1024
    ds_read_b32 v45, v113 offset:9728
    ds_read_b32 v46, v113 offset:18432
    ds_read_b32 v47, v113 offset:27136
    ds_read_b32 v48, v113 offset:2048
    ds_read_b32 v49, v113 offset:10752
    ds_read_b32 v50, v113 offset:19456
    ds_read_b32 v51, v113 offset:28160
    ds_write_b16 v114, v12 offset:5160
    s_waitcnt lgkmcnt(1)
    v_add_f32 v40, v40, v41
    v_add_f32 v42, v42, v43
    v_add_f32 v44, v44, v45
    v_add_f32 v46, v46, v47
    v_add_f32 v48, v48, v49
    v_add_f32 v50, v50, v51
    v_add_f32 v40, v40, v118
    v_add_f32 v40, v40, v42
    v_add_f32 v44, v44, v46
    v_add_f32 v48, v48, v50
    v_cvt_pk_bf16_f32 v52, v40, v44
    v_cvt_pk_bf16_f32 v53, v48, v48
    ds_write_b16 v110, v52
    ds_write_b16_d16_hi v111, v52
    ds_write_b16 v112, v53
    s_waitcnt lgkmcnt(0)
    s_mov_b64 exec, 1
    ds_add_u32 v119, v128 offset:12
    s_mov_b64 exec, -1
    s_mov_b32 s47, 0
AS2_spin:
    ds_read_b32 v16, v119 offset:12
    s_add_u32 s47, s47, 1
    s_waitcnt lgkmcnt(0)
    v_readfirstlane_b32 s15, v16
    s_nop 0
    s_cmp_ge_u32 s15, 5
    s_cbranch_scc1 AS2_go
    s_cmp_lt_u32 s47, 2000000
    s_cbranch_scc1 AS2_spin
AS2_go:
    ds_read_u16 v60, v129
    ds_read_u16 v61, v130
    ds_read_u16 v62, v131
    ds_read_u16 v63, v132
    ds_read_u16 v64, v133
    ds_read_u16 v65, v134
    ds_read_u16 v66, v135
    ds_read_u16 v67, v136
    ds_read_u16 v68, v137
    ds_read_u16 v69, v138
    ds_read_u16 v70, v139
    s_cmp_ge_u32 s6, 2
    s_cbranch_scc1 A_noz
    v_bfe_u32 v17, v2, 2, 2
    v_mul_u32_u24 v17, 4160, v17
    v_and_b32 v18, 3, v2
    v_lshl_add_u32 v17, v18, 4, v17
    v_add_u32 v17, 4096, v17
    v_and_b32 v18, 31, v2
    v_lshlrev_b32 v18, 4, v18
    v_add_u32 v18, 16640, v18
    s_cmp_eq_u32 s6, 0
    s_cselect_b64 vcc, -1, 0
    v_cndmask_b32 v17, v18, v17, vcc
    v_add_u32 v17, s34, v17
    ds_write_b128 v17, v[12:15]
A_noz:
    s_waitcnt lgkmcnt(0)
    v_lshl_or_b32 v72, v61, 16, v60
    v_lshl_or_b32 v73, v63, 16, v62
    v_lshl_or_b32 v74, v65, 16, v64
    v_lshl_or_b32 v75, v67, 16, v66
    ds_write_b128 v126, v[72:75] offset:0
    v_lshl_or_b32 v76, v62, 16, v61
    v_lshl_or_b32 v77, v64, 16, v63
    v_lshl_or_b32 v78, v66, 16, v65
    v_lshl_or_b32 v79, v68, 16, v67
    ds_write_b128 v126, v[76:79] offset:4160
    v_lshl_or_b32 v80, v63, 16, v62
    v_lshl_or_b32 v81, v65, 16, v64
    v_lshl_or_b32 v82, v67, 16, v66
    v_lshl_or_b32 v83, v69, 16, v68
    ds_write_b128 v126, v[80:83] offset:8320
    v_lshl_or_b32 v84, v64, 16, v63
    v_lshl_or_b32 v85, v66, 16, v65
    v_lshl_or_b32 v86, v68, 16, v67
    v_lshl_or_b32 v87, v70, 16, v69
    ds_write_b128 v126, v[84:87] offset:12480
    s_waitcnt lgkmcnt(0)
    s_mov_b64 exec, 1
    ds_add_u32 v127, v128 offset:20
    s_mov_b64 exec, -1
    s_branch A_kgdone
A_nokg:
    v_mov_b32 v109, 0
    s_waitcnt lgkmcnt(0)
    s_barrier
    s_add_u32 s48, s42, 0xc20000
    s_addc_u32 s49, s43, 0
    s_load_dword s46, s[48:49], 0
    s_mov_b32 s50, 0x40000
    s_mov_b32 s51, 0x20000
    s_add_u32 s52, s42, 0x200000
    s_addc_u32 s53, s43, 0
    s_mov_b32 s54, 0x40000
    s_mov_b32 s55, 0x20000
    s_waitcnt lgkmcnt(0)
    s_mul_i32 s46, s46, 0x9E3779B1
    s_add_u32 s46, s46, 0x7F4A7C15
    s_mov_b64 exec, 1
    ds_add_u32 v127, v128 offset:20
    s_mov_b64 exec, -1
A_kgdone:
    s_lshl_b32 s13, s44, 4
    s_add_u32 s13, s13, 2048
    s_cmp_lg_u32 s5, 0
    s_cbranch_scc1 A_g1pre
    s_lshr_b32 s16, s6, 1
    s_and_b32 s17, s6, 1
    s_mul_i32 s14, s16, 21248
    s_add_u32 s14, s14, 98304
    s_lshl_b32 s12, s8, 1
    s_add_u32 s12, s12, s16
    s_lshl_b32 s18, s12, 12
    s_cmp_eq_u32 s7, 7
    s_cbranch_scc1 A_pre_done
    s_cmp_lg_u32 s6, 0
    s_cbranch_scc1 A_nopoll
    s_mov_b32 s47, 0
AUF_spin:
    ds_read_b32 v10, v127 offset:40
    s_add_u32 s47, s47, 1
    s_waitcnt lgkmcnt(0)
    v_readfirstlane_b32 s15, v10
    s_nop 0
    s_cmp_ge_u32 s15, 1
    s_cbranch_scc1 AUF_go
    s_cmp_lt_u32 s47, 2000000
    s_cbranch_scc1 AUF_spin
AUF_go:
    s_mov_b32 s47, 0
AU_poll:
    buffer_load_dword v10, v109, s[48:51], 0 offen sc1
    s_add_u32 s47, s47, 1
    s_waitcnt vmcnt(0)
    v_xor_b32 v10, s46, v10
    v_cmp_ne_u32 vcc, 0, v10
    s_cbranch_vccz AU_ok
    s_mov_b64 exec, vcc
    s_cmp_lt_u32 s47, 400000
    s_sleep 6
    s_cbranch_scc1 AU_poll
AU_ok:
    s_mov_b64 exec, -1
    s_mov_b64 exec, 1
    ds_add_u32 v127, v128 offset:48
    s_mov_b64 exec, -1
A_nopoll:
    s_add_u32 s56, s42, 0x8a0000
    s_addc_u32 s57, s43, 0
    s_mov_b32 s58, 0x1c0000
    s_mov_b32 s59, 0x20000
    s_lshl_b32 s10, s17, 11
    s_add_u32 s11, s10, s14
    s_add_u32 s10, s10, s18
    s_mov_b32 s47, 0
AKC_spin:
    ds_read_b32 v10, v127 offset:16
    s_add_u32 s47, s47, 1
    s_waitcnt lgkmcnt(0)
    v_readfirstlane_b32 s15, v10
    s_nop 0
    s_cmp_ge_u32 s15, 1
    s_cbranch_scc1 AKC_go
    s_cmp_lt_u32 s47, 2000000
    s_cbranch_scc1 AKC_spin
AKC_go:
    s_mov_b32 s47, 0
AUO_spin:
    ds_read_b32 v10, v127 offset:48
    s_add_u32 s47, s47, 1
    s_waitcnt lgkmcnt(0)
    v_readfirstlane_b32 s15, v10
    s_nop 0
    s_cmp_ge_u32 s15, 1
    s_cbranch_scc1 AUO_go
    s_cmp_lt_u32 s47, 2000000
    s_sleep 1
    s_cbranch_scc1 AUO_spin
AUO_go:
    s_add_u32 m0, s11, 17152
    s_nop 0
    buffer_load_dwordx4 v3, s[56:59], s10 offen sc1 lds
    buffer_load_dwordx4 v3, s[56:59], s10 offen offset:1024 sc1 lds
    s_add_u32 s56, s42, 0xa60000
    s_addc_u32 s57, s43, 0
    s_mov_b32 s58, 0x1c0000
    s_mov_b32 s59, 0x20000
    v_and_b32 v20, 15, v2
    v_lshrrev_b32 v21, 4, v2
    v_xor_b32 v6, 3, v20
    v_and_b32 v6, 3, v6
    v_lshlrev_b32 v7, 3, v21
    v_sub_u32 v7, v7, v20
    v_sub_u32 v7, v7, v6
    v_add_u32 v7, 175, v7
    v_mul_u32_u24 v6, 4160, v6
    v_lshl_add_u32 v6, v7, 1, v6
    v_add_u32 v6, s14, v6
    v_lshlrev_b32 v7, 5, v20
    v_lshl_add_u32 v7, v21, 4, v7
    s_add_u32 s10, s14, 16992
    v_add_u32 v7, s10, v7
    v_lshlrev_b32 v8, 5, v20
    v_lshl_add_u32 v8, v21, 3, v8
    v_mov_b32 v16, 0
    v_mov_b32 v17, 0
    v_mov_b32 v18, 0
    v_mov_b32 v19, 0
    v_mov_b32 v20, 0
    v_mov_b32 v21, 0
    v_mov_b32 v22, 0
    v_mov_b32 v23, 0
    v_mov_b32 v24, 0
    v_mov_b32 v25, 0
    v_mov_b32 v26, 0
    v_mov_b32 v27, 0
    v_mov_b32 v28, 0
    v_mov_b32 v29, 0
    v_mov_b32 v30, 0
    v_mov_b32 v31, 0
    s_mov_b32 s10, 0
    s_waitcnt vmcnt(0)
    s_mov_b64 exec, 1
    ds_add_u32 v127, v128 offset:32
    s_mov_b64 exec, -1
    s_mov_b32 s47, 0
AUW_spin:
    ds_read_b32 v10, v127 offset:32
    s_add_u32 s47, s47, 1
    s_waitcnt lgkmcnt(0)
    v_readfirstlane_b32 s15, v10
    s_nop 0
    s_cmp_ge_u32 s15, 4
    s_cbranch_scc1 AUW_go
    s_cmp_lt_u32 s47, 2000000
    s_cbranch_scc1 AUW_spin
AUW_go:
    s_mov_b32 s47, 0
AKG_spin:
    ds_read_b32 v10, v127 offset:20
    s_add_u32 s47, s47, 1
    s_waitcnt lgkmcnt(0)
    v_readfirstlane_b32 s15, v10
    s_nop 0
    s_cmp_ge_u32 s15, 8
    s_cbranch_scc1 AKG_go
    s_cmp_lt_u32 s47, 2000000
    s_sleep 1
    s_cbranch_scc1 AKG_spin
AKG_go:
    s_setprio 0
    s_cmp_eq_u32 s17, 1
    s_cbranch_scc1 A_conv1
    ds_read_b128 v[64:67], v7 offset:128
    ds_read_b64 v[32:33], v6 offset:3712
    ds_read_b64 v[34:35], v6 offset:3720
    ds_read_b128 v[68:71], v7 offset:640
    ds_read_b64 v[36:37], v6 offset:3200
    ds_read_b64 v[38:39], v6 offset:3208
    ds_read_b128 v[72:75], v7 offset:1152
    ds_read_b64 v[40:41], v6 offset:2688
    ds_read_b64 v[42:43], v6 offset:2696
    ds_read_b128 v[76:79], v7 offset:1664
    ds_read_b64 v[44:45], v6 offset:2176
    ds_read_b64 v[46:47], v6 offset:2184
    ds_read_b128 v[80:83], v7 offset:2176
    ds_read_b64 v[48:49], v6 offset:1664
    ds_read_b64 v[50:51], v6 offset:1672
    ds_read_b128 v[84:87], v7 offset:2688
    ds_read_b64 v[52:53], v6 offset:1152
    ds_read_b64 v[54:55], v6 offset:1160
    ds_read_b128 v[88:91], v7 offset:3200
    ds_read_b64 v[56:57], v6 offset:640
    ds_read_b64 v[58:59], v6 offset:648
    ds_read_b128 v[92:95], v7 offset:3712
    ds_read_b64 v[60:61], v6 offset:128
    ds_read_b64 v[62:63], v6 offset:136
A_cl0:
    s_waitcnt lgkmcnt(15)
    v_mfma_f32_16x16x32_bf16 v[16:19], v[32:35], v[64:67], v[16:19]
    ds_read_b128 v[96:99], v7 offset:64
    s_waitcnt lgkmcnt(15)
    v_mfma_f32_16x16x32_bf16 v[20:23], v[32:35], v[76:79], v[20:23]
    ds_read_b64 v[128:129], v6 offset:3648
    ds_read_b64 v[130:131], v6 offset:3656
    s_waitcnt lgkmcnt(14)
    v_mfma_f32_16x16x32_bf16 v[24:27], v[32:35], v[80:83], v[24:27]
    ds_read_b128 v[100:103], v7 offset:576
    s_waitcnt lgkmcnt(6)
    v_mfma_f32_16x16x32_bf16 v[28:31], v[32:35], v[92:95], v[28:31]
    ds_read_b64 v[132:133], v6 offset:3136
    ds_read_b64 v[134:135], v6 offset:3144
    v_mfma_f32_16x16x32_bf16 v[20:23], v[36:39], v[72:75], v[20:23]
    ds_read_b128 v[104:107], v7 offset:1088
    v_mfma_f32_16x16x32_bf16 v[24:27], v[36:39], v[76:79], v[24:27]
    ds_read_b64 v[136:137], v6 offset:2624
    ds_read_b64 v[138:139], v6 offset:2632
    v_mfma_f32_16x16x32_bf16 v[28:31], v[36:39], v[88:91], v[28:31]
    ds_read_b128 v[108:111], v7 offset:1600
    v_mfma_f32_16x16x32_bf16 v[20:23], v[40:43], v[68:71], v[20:23]
    ds_read_b64 v[140:141], v6 offset:2112
    ds_read_b64 v[142:143], v6 offset:2120
    v_mfma_f32_16x16x32_bf16 v[24:27], v[40:43], v[72:75], v[24:27]
    ds_read_b128 v[112:115], v7 offset:2112
    v_mfma_f32_16x16x32_bf16 v[28:31], v[40:43], v[84:87], v[28:31]
    ds_read_b64 v[144:145], v6 offset:1600
    ds_read_b64 v[146:147], v6 offset:1608
    v_mfma_f32_16x16x32_bf16 v[20:23], v[44:47], v[64:67], v[20:23]
    ds_read_b128 v[116:119], v7 offset:2624
    v_mfma_f32_16x16x32_bf16 v[24:27], v[44:47], v[68:71], v[24:27]
    ds_read_b64 v[148:149], v6 offset:1088
    ds_read_b64 v[150:151], v6 offset:1096
    v_mfma_f32_16x16x32_bf16 v[28:31], v[44:47], v[80:83], v[28:31]
    ds_read_b128 v[120:123], v7 offset:3136
    v_mfma_f32_16x16x32_bf16 v[24:27], v[48:51], v[64:67], v[24:27]
    ds_read_b64 v[152:153], v6 offset:576
    ds_read_b64 v[154:155], v6 offset:584
    v_mfma_f32_16x16x32_bf16 v[28:31], v[48:51], v[76:79], v[28:31]
    ds_read_b128 v[124:127], v7 offset:3648
    v_mfma_f32_16x16x32_bf16 v[28:31], v[52:55], v[72:75], v[28:31]
    ds_read_b64 v[156:157], v6 offset:64
    ds_read_b64 v[158:159], v6 offset:72
    v_mfma_f32_16x16x32_bf16 v[28:31], v[56:59], v[68:71], v[28:31]
    s_waitcnt lgkmcnt(15)
    v_mfma_f32_16x16x32_bf16 v[28:31], v[60:63], v[64:67], v[28:31]
    v_mfma_f32_16x16x32_bf16 v[16:19], v[128:131], v[96:99], v[16:19]
    ds_read_b128 v[64:67], v7 offset:0
    s_waitcnt lgkmcnt(15)
    v_mfma_f32_16x16x32_bf16 v[20:23], v[128:131], v[108:111], v[20:23]
    ds_read_b64 v[32:33], v6 offset:3584
    ds_read_b64 v[34:35], v6 offset:3592
    s_waitcnt lgkmcnt(14)
    v_mfma_f32_16x16x32_bf16 v[24:27], v[128:131], v[112:115], v[24:27]
    ds_read_b128 v[68:71], v7 offset:512
    s_waitcnt lgkmcnt(6)
    v_mfma_f32_16x16x32_bf16 v[28:31], v[128:131], v[124:127], v[28:31]
    ds_read_b64 v[36:37], v6 offset:3072
    ds_read_b64 v[38:39], v6 offset:3080
    v_mfma_f32_16x16x32_bf16 v[20:23], v[132:135], v[104:107], v[20:23]
    ds_read_b128 v[72:75], v7 offset:1024
    v_mfma_f32_16x16x32_bf16 v[24:27], v[132:135], v[108:111], v[24:27]
    ds_read_b64 v[40:41], v6 offset:2560
    ds_read_b64 v[42:43], v6 offset:2568
    v_mfma_f32_16x16x32_bf16 v[28:31], v[132:135], v[120:123], v[28:31]
    ds_read_b128 v[76:79], v7 offset:1536
    v_mfma_f32_16x16x32_bf16 v[20:23], v[136:139], v[100:103], v[20:23]
    ds_read_b64 v[44:45], v6 offset:2048
    ds_read_b64 v[46:47], v6 offset:2056
    v_mfma_f32_16x16x32_bf16 v[24:27], v[136:139], v[104:107], v[24:27]
    ds_read_b128 v[80:83], v7 offset:2048
    v_mfma_f32_16x16x32_bf16 v[28:31], v[136:139], v[116:119], v[28:31]
    ds_read_b64 v[48:49], v6 offset:1536
    ds_read_b64 v[50:51], v6 offset:1544
    v_mfma_f32_16x16x32_bf16 v[20:23], v[140:143], v[96:99], v[20:23]
    ds_read_b128 v[84:87], v7 offset:2560
    v_mfma_f32_16x16x32_bf16 v[24:27], v[140:143], v[100:103], v[24:27]
    ds_read_b64 v[52:53], v6 offset:1024
    ds_read_b64 v[54:55], v6 offset:1032
    v_mfma_f32_16x16x32_bf16 v[28:31], v[140:143], v[112:115], v[28:31]
    ds_read_b128 v[88:91], v7 offset:3072
    v_mfma_f32_16x16x32_bf16 v[24:27], v[144:147], v[96:99], v[24:27]
    ds_read_b64 v[56:57], v6 offset:512
    ds_read_b64 v[58:59], v6 offset:520
    v_mfma_f32_16x16x32_bf16 v[28:31], v[144:147], v[108:111], v[28:31]
    ds_read_b128 v[92:95], v7 offset:3584
    v_mfma_f32_16x16x32_bf16 v[28:31], v[148:151], v[104:107], v[28:31]
    ds_read_b64 v[60:61], v6 offset:0
    ds_read_b64 v[62:63], v6 offset:8
    v_mfma_f32_16x16x32_bf16 v[28:31], v[152:155], v[100:103], v[28:31]
    s_waitcnt lgkmcnt(15)
    v_mfma_f32_16x16x32_bf16 v[28:31], v[156:159], v[96:99], v[28:31]
    v_subrev_u32 v6, 128, v6
    v_subrev_u32 v7, 128, v7
    s_add_u32 s10, s10, 1
    s_cmp_lt_u32 s10, 4
    s_cbranch_scc1 A_cl0
    v_cvt_pk_bf16_f32 v16, v16, v17
    v_cvt_pk_bf16_f32 v17, v18, v19
    buffer_store_dwordx2 v[16:17], v8, s[56:59], s18 offen offset:0 sc1
    v_cvt_pk_bf16_f32 v20, v20, v21
    v_cvt_pk_bf16_f32 v21, v22, v23
    buffer_store_dwordx2 v[20:21], v8, s[56:59], s18 offen offset:1536 sc1
    v_cvt_pk_bf16_f32 v24, v24, v25
    v_cvt_pk_bf16_f32 v25, v26, v27
    buffer_store_dwordx2 v[24:25], v8, s[56:59], s18 offen offset:2048 sc1
    v_cvt_pk_bf16_f32 v28, v28, v29
    v_cvt_pk_bf16_f32 v29, v30, v31
    buffer_store_dwordx2 v[28:29], v8, s[56:59], s18 offen offset:3584 sc1
    s_waitcnt lgkmcnt(0)
    s_branch A_pre_done
A_conv1:
    ds_read_b128 v[64:67], v7 offset:128
    ds_read_b64 v[32:33], v6 offset:3712
    ds_read_b64 v[34:35], v6 offset:3720
    ds_read_b128 v[68:71], v7 offset:640
    ds_read_b64 v[36:37], v6 offset:3200
    ds_read_b64 v[38:39], v6 offset:3208
    ds_read_b128 v[72:75], v7 offset:1152
    ds_read_b64 v[40:41], v6 offset:2688
    ds_read_b64 v[42:43], v6 offset:2696
    ds_read_b128 v[76:79], v7 offset:1664
    ds_read_b64 v[44:45], v6 offset:2176
    ds_read_b64 v[46:47], v6 offset:2184
    ds_read_b128 v[80:83], v7 offset:2176
    ds_read_b64 v[48:49], v6 offset:1664
    ds_read_b64 v[50:51], v6 offset:1672
    ds_read_b128 v[84:87], v7 offset:2688
    ds_read_b64 v[52:53], v6 offset:1152
    ds_read_b64 v[54:55], v6 offset:1160
    ds_read_b128 v[88:91], v7 offset:3200
    ds_read_b64 v[56:57], v6 offset:640
    ds_read_b64 v[58:59], v6 offset:648
A_cl1:
    s_waitcnt lgkmcnt(15)
    v_mfma_f32_16x16x32_bf16 v[16:19], v[32:35], v[68:71], v[16:19]
    ds_read_b128 v[96:99], v7 offset:64
    s_waitcnt lgkmcnt(15)
    v_mfma_f32_16x16x32_bf16 v[20:23], v[32:35], v[72:75], v[20:23]
    ds_read_b64 v[128:129], v6 offset:3648
    ds_read_b64 v[130:131], v6 offset:3656
    s_waitcnt lgkmcnt(8)
    v_mfma_f32_16x16x32_bf16 v[24:27], v[32:35], v[84:87], v[24:27]
    ds_read_b128 v[100:103], v7 offset:576
    s_waitcnt lgkmcnt(6)
    v_mfma_f32_16x16x32_bf16 v[28:31], v[32:35], v[88:91], v[28:31]
    ds_read_b64 v[132:133], v6 offset:3136
    ds_read_b64 v[134:135], v6 offset:3144
    v_mfma_f32_16x16x32_bf16 v[16:19], v[36:39], v[64:67], v[16:19]
    ds_read_b128 v[104:107], v7 offset:1088
    v_mfma_f32_16x16x32_bf16 v[20:23], v[36:39], v[68:71], v[20:23]
    ds_read_b64 v[136:137], v6 offset:2624
    ds_read_b64 v[138:139], v6 offset:2632
    v_mfma_f32_16x16x32_bf16 v[24:27], v[36:39], v[80:83], v[24:27]
    ds_read_b128 v[108:111], v7 offset:1600
    v_mfma_f32_16x16x32_bf16 v[28:31], v[36:39], v[84:87], v[28:31]
    ds_read_b64 v[140:141], v6 offset:2112
    ds_read_b64 v[142:143], v6 offset:2120
    v_mfma_f32_16x16x32_bf16 v[20:23], v[40:43], v[64:67], v[20:23]
    ds_read_b128 v[112:115], v7 offset:2112
    v_mfma_f32_16x16x32_bf16 v[24:27], v[40:43], v[76:79], v[24:27]
    ds_read_b64 v[144:145], v6 offset:1600
    ds_read_b64 v[146:147], v6 offset:1608
    v_mfma_f32_16x16x32_bf16 v[28:31], v[40:43], v[80:83], v[28:31]
    ds_read_b128 v[116:119], v7 offset:2624
    v_mfma_f32_16x16x32_bf16 v[24:27], v[44:47], v[72:75], v[24:27]
    ds_read_b64 v[148:149], v6 offset:1088
    ds_read_b64 v[150:151], v6 offset:1096
    v_mfma_f32_16x16x32_bf16 v[28:31], v[44:47], v[76:79], v[28:31]
    ds_read_b128 v[120:123], v7 offset:3136
    v_mfma_f32_16x16x32_bf16 v[24:27], v[48:51], v[68:71], v[24:27]
    ds_read_b64 v[152:153], v6 offset:576
    ds_read_b64 v[154:155], v6 offset:584
    v_mfma_f32_16x16x32_bf16 v[28:31], v[48:51], v[72:75], v[28:31]
    v_mfma_f32_16x16x32_bf16 v[24:27], v[52:55], v[64:67], v[24:27]
    v_mfma_f32_16x16x32_bf16 v[28:31], v[52:55], v[68:71], v[28:31]
    s_waitcnt lgkmcnt(15)
    v_mfma_f32_16x16x32_bf16 v[28:31], v[56:59], v[64:67], v[28:31]
    v_mfma_f32_16x16x32_bf16 v[16:19], v[128:131], v[100:103], v[16:19]
    ds_read_b128 v[64:67], v7 offset:0
    s_waitcnt lgkmcnt(15)
    v_mfma_f32_16x16x32_bf16 v[20:23], v[128:131], v[104:107], v[20:23]
    ds_read_b64 v[32:33], v6 offset:3584
    ds_read_b64 v[34:35], v6 offset:3592
    s_waitcnt lgkmcnt(8)
    v_mfma_f32_16x16x32_bf16 v[24:27], v[128:131], v[116:119], v[24:27]
    ds_read_b128 v[68:71], v7 offset:512
    s_waitcnt lgkmcnt(6)
    v_mfma_f32_16x16x32_bf16 v[28:31], v[128:131], v[120:123], v[28:31]
    ds_read_b64 v[36:37], v6 offset:3072
    ds_read_b64 v[38:39], v6 offset:3080
    v_mfma_f32_16x16x32_bf16 v[16:19], v[132:135], v[96:99], v[16:19]
    ds_read_b128 v[72:75], v7 offset:1024
    v_mfma_f32_16x16x32_bf16 v[20:23], v[132:135], v[100:103], v[20:23]
    ds_read_b64 v[40:41], v6 offset:2560
    ds_read_b64 v[42:43], v6 offset:2568
    v_mfma_f32_16x16x32_bf16 v[24:27], v[132:135], v[112:115], v[24:27]
    ds_read_b128 v[76:79], v7 offset:1536
    v_mfma_f32_16x16x32_bf16 v[28:31], v[132:135], v[116:119], v[28:31]
    ds_read_b64 v[44:45], v6 offset:2048
    ds_read_b64 v[46:47], v6 offset:2056
    v_mfma_f32_16x16x32_bf16 v[20:23], v[136:139], v[96:99], v[20:23]
    ds_read_b128 v[80:83], v7 offset:2048
    v_mfma_f32_16x16x32_bf16 v[24:27], v[136:139], v[108:111], v[24:27]
    ds_read_b64 v[48:49], v6 offset:1536
    ds_read_b64 v[50:51], v6 offset:1544
    v_mfma_f32_16x16x32_bf16 v[28:31], v[136:139], v[112:115], v[28:31]
    ds_read_b128 v[84:87], v7 offset:2560
    v_mfma_f32_16x16x32_bf16 v[24:27], v[140:143], v[104:107], v[24:27]
    ds_read_b64 v[52:53], v6 offset:1024
    ds_read_b64 v[54:55], v6 offset:1032
    v_mfma_f32_16x16x32_bf16 v[28:31], v[140:143], v[108:111], v[28:31]
    ds_read_b128 v[88:91], v7 offset:3072
    v_mfma_f32_16x16x32_bf16 v[24:27], v[144:147], v[100:103], v[24:27]
    ds_read_b64 v[56:57], v6 offset:512
    ds_read_b64 v[58:59], v6 offset:520
    v_mfma_f32_16x16x32_bf16 v[28:31], v[144:147], v[104:107], v[28:31]
    v_mfma_f32_16x16x32_bf16 v[24:27], v[148:151], v[96:99], v[24:27]
    v_mfma_f32_16x16x32_bf16 v[28:31], v[148:151], v[100:103], v[28:31]
    s_waitcnt lgkmcnt(15)
    v_mfma_f32_16x16x32_bf16 v[28:31], v[152:155], v[96:99], v[28:31]
    v_subrev_u32 v6, 128, v6
    v_subrev_u32 v7, 128, v7
    s_add_u32 s10, s10, 1
    s_cmp_lt_u32 s10, 4
    s_cbranch_scc1 A_cl1
    v_cvt_pk_bf16_f32 v16, v16, v17
    v_cvt_pk_bf16_f32 v17, v18, v19
    buffer_store_dwordx2 v[16:17], v8, s[56:59], s18 offen offset:512 sc1
    v_cvt_pk_bf16_f32 v20, v20, v21
    v_cvt_pk_bf16_f32 v21, v22, v23
    buffer_store_dwordx2 v[20:21], v8, s[56:59], s18 offen offset:1024 sc1
    v_cvt_pk_bf16_f32 v24, v24, v25
    v_cvt_pk_bf16_f32 v25, v26, v27
    buffer_store_dwordx2 v[24:25], v8, s[56:59], s18 offen offset:2560 sc1
    v_cvt_pk_bf16_f32 v28, v28, v29
    v_cvt_pk_bf16_f32 v29, v30, v31
    buffer_store_dwordx2 v[28:29], v8, s[56:59], s18 offen offset:3072 sc1
    s_waitcnt lgkmcnt(0)
    s_branch A_pre_done
A_g1pre:
    s_cmp_lg_u32 s6, 0
    s_cbranch_scc1 A_nokp
    v_lshlrev_b32 v8, 7, v2
    v_add_u32 v8, 16384, v8
    v_add_u32 v9, 0x2000, v8
    s_mov_b32 s47, 0
APF_spin:
    ds_read_b32 v10, v127 offset:40
    s_add_u32 s47, s47, 1
    s_waitcnt lgkmcnt(0)
    v_readfirstlane_b32 s15, v10
    s_nop 0
    s_cmp_ge_u32 s15, 1
    s_cbranch_scc1 APF_go
    s_cmp_lt_u32 s47, 2000000
    s_cbranch_scc1 APF_spin
APF_go:
    s_cmp_lg_u32 s7, 7
    s_cbranch_scc1 A_nopd
    s_sleep 40
A_nopd:
    s_mov_b32 s47, 0
AK_poll:
    buffer_load_dword v10, v8, s[48:51], 0 offen sc1
    buffer_load_dword v11, v9, s[48:51], 0 offen sc1
    s_add_u32 s47, s47, 1
    s_waitcnt vmcnt(0)
    v_xor_b32 v10, s46, v10
    v_xor_b32 v11, s46, v11
    v_or_b32 v10, v10, v11
    v_cmp_ne_u32 vcc, 0, v10
    s_cbranch_vccz AK_ok
    s_mov_b64 exec, vcc
    s_cmp_lt_u32 s47, 400000
    s_sleep 4
    s_cbranch_scc1 AK_poll
AK_ok:
    s_mov_b64 exec, -1
    s_mov_b64 exec, 1
    ds_add_u32 v127, v128 offset:36
    s_mov_b64 exec, -1
A_nokp:
    s_mov_b32 s47, 0
AKG1_spin:
    ds_read_b32 v10, v127 offset:20
    s_add_u32 s47, s47, 1
    s_waitcnt lgkmcnt(0)
    v_readfirstlane_b32 s15, v10
    s_nop 0
    s_cmp_ge_u32 s15, 8
    s_cbranch_scc1 AKG1_go
    s_cmp_lt_u32 s47, 2000000
    s_sleep 2
    s_cbranch_scc1 AKG1_spin
AKG1_go:
    s_mov_b32 s47, 0
AKF1_spin:
    ds_read_b32 v10, v127 offset:36
    s_add_u32 s47, s47, 1
    s_waitcnt lgkmcnt(0)
    v_readfirstlane_b32 s15, v10
    s_nop 0
    s_cmp_ge_u32 s15, 1
    s_cbranch_scc1 AKF1_go
    s_cmp_lt_u32 s47, 2000000
    s_sleep 2
    s_cbranch_scc1 AKF1_spin
AKF1_go:
    s_lshl_b32 s10, s6, 13
    s_add_u32 m0, s10, 0
    s_add_u32 s11, s10, 0
    buffer_load_dwordx4 v3, s[52:55], s11 offen offset:0 sc1 lds
    buffer_load_dwordx4 v3, s[52:55], s11 offen offset:1024 sc1 lds
    buffer_load_dwordx4 v3, s[52:55], s11 offen offset:2048 sc1 lds
    buffer_load_dwordx4 v3, s[52:55], s11 offen offset:3072 sc1 lds
    s_add_u32 m0, s10, 4096
    s_add_u32 s11, s10, 4096
    buffer_load_dwordx4 v3, s[52:55], s11 offen offset:0 sc1 lds
    buffer_load_dwordx4 v3, s[52:55], s11 offen offset:1024 sc1 lds
    buffer_load_dwordx4 v3, s[52:55], s11 offen offset:2048 sc1 lds
    buffer_load_dwordx4 v3, s[52:55], s11 offen offset:3072 sc1 lds
    s_add_u32 m0, s10, 32768
    s_add_u32 s11, s10, 32768
    buffer_load_dwordx4 v3, s[52:55], s11 offen offset:0 sc1 lds
    buffer_load_dwordx4 v3, s[52:55], s11 offen offset:1024 sc1 lds
    buffer_load_dwordx4 v3, s[52:55], s11 offen offset:2048 sc1 lds
    buffer_load_dwordx4 v3, s[52:55], s11 offen offset:3072 sc1 lds
    s_add_u32 m0, s10, 36864
    s_add_u32 s11, s10, 36864
    buffer_load_dwordx4 v3, s[52:55], s11 offen offset:0 sc1 lds
    buffer_load_dwordx4 v3, s[52:55], s11 offen offset:1024 sc1 lds
    buffer_load_dwordx4 v3, s[52:55], s11 offen offset:2048 sc1 lds
    buffer_load_dwordx4 v3, s[52:55], s11 offen offset:3072 sc1 lds
    s_waitcnt vmcnt(8)
A_pre_done:
    v_mov_b32 v106, 0
    buffer_load_dwordx4 v[108:111], v106, s[48:51], s13 offen sc1
    s_lshl_b32 s4, s45, 2
    s_add_u32 s4, s4, s6
    s_lshl_b32 s10, s44, 4
    s_add_u32 s10, s10, s4
    s_lshl_b32 s35, s10, 11
    s_lshl_b32 s36, s5, 14
    v_add_u32 v4, s36, v3
    v_add_u32 v5, 32768, v4
    s_add_u32 s56, s42, 0x280000
    s_addc_u32 s57, s43, 0
    s_mov_b32 s58, 0x200000
    s_mov_b32 s59, 0x20000
    v_mov_b32 v16, 0
    v_mov_b32 v17, 0
    v_mov_b32 v18, 0
    v_mov_b32 v19, 0
    v_mov_b32 v20, 0
    v_mov_b32 v21, 0
    v_mov_b32 v22, 0
    v_mov_b32 v23, 0
    v_mov_b32 v24, 0
    v_mov_b32 v25, 0
    v_mov_b32 v26, 0
    v_mov_b32 v27, 0
    v_mov_b32 v28, 0
    v_mov_b32 v29, 0
    v_mov_b32 v30, 0
    v_mov_b32 v31, 0
    v_mov_b32 v68, 0
    v_mov_b32 v69, 0
    v_mov_b32 v70, 0
    v_mov_b32 v71, 0
    v_mov_b32 v100, 0
    v_mov_b32 v101, 0
    v_mov_b32 v102, 0
    v_mov_b32 v103, 0
    v_mov_b32 v60, 0
    v_mov_b32 v61, 0
    v_mov_b32 v62, 0
    v_mov_b32 v63, 0
    s_mul_i32 s13, s6, 5120
    s_add_u32 s13, s13, 140800
    v_add_u32 v6, s13, v3
    s_mov_b32 s10, 0
    s_mov_b32 s11, 32768
    s_barrier
    ds_read_b128 v[8:11], v6
    ds_read_b128 v[12:15], v6 offset:1024
    ds_read_b128 v[72:75], v4
    ds_read_b128 v[76:79], v4 offset:1024
    ds_read_b128 v[80:83], v4 offset:4096
    ds_read_b128 v[84:87], v4 offset:5120
    ds_read_b128 v[88:91], v4 offset:2048
    ds_read_b128 v[92:95], v4 offset:3072
    s_waitcnt lgkmcnt(4)
    v_mfma_f32_32x32x16_bf16 v[32:47], v[72:75], v[8:11], 0
    v_mfma_f32_32x32x16_bf16 v[32:47], v[76:79], v[12:15], v[32:47]
    s_nop 5
.p2align 6
A_loop:
    s_setprio 0
    s_waitcnt lgkmcnt(1)
    v_cvt_pk_bf16_f32 v70, v60, v61
    v_cvt_pk_bf16_f32 v71, v62, v63
    v_mfma_f32_32x32x16_bf16 v[48:63], v[80:83], v[8:11], 0
    ds_read_b128 v[72:75], v4 offset:8192
    v_exp_f32 v32, v32
    v_exp_f32 v33, v33
    v_exp_f32 v34, v34
    v_exp_f32 v35, v35
    v_mfma_f32_32x32x16_bf16 v[16:31], v[100:103], v[68:71], v[16:31]
    ds_read_b128 v[76:79], v4 offset:9216
    v_cvt_pk_bf16_f32 v64, v32, v33
    v_cvt_pk_bf16_f32 v65, v34, v35
    v_exp_f32 v36, v36
    v_exp_f32 v37, v37
    v_exp_f32 v38, v38
    v_exp_f32 v39, v39
    v_mfma_f32_32x32x16_bf16 v[48:63], v[84:87], v[12:15], v[48:63]
    ds_read_b128 v[96:99], v4 offset:6144
    v_cvt_pk_bf16_f32 v66, v36, v37
    v_cvt_pk_bf16_f32 v67, v38, v39
    v_exp_f32 v40, v40
    v_exp_f32 v41, v41
    v_exp_f32 v42, v42
    v_exp_f32 v43, v43
    v_mfma_f32_32x32x16_bf16 v[16:31], v[88:91], v[64:67], v[16:31]
    ds_read_b128 v[100:103], v4 offset:7168
    v_cvt_pk_bf16_f32 v68, v40, v41
    v_cvt_pk_bf16_f32 v69, v42, v43
    v_exp_f32 v44, v44
    v_exp_f32 v45, v45
    v_exp_f32 v46, v46
    v_exp_f32 v47, v47
    s_setprio 0
    s_waitcnt lgkmcnt(1)
    v_cvt_pk_bf16_f32 v70, v44, v45
    v_cvt_pk_bf16_f32 v71, v46, v47
    v_mfma_f32_32x32x16_bf16 v[32:47], v[72:75], v[8:11], 0
    ds_read_b128 v[80:83], v4 offset:12288
    v_exp_f32 v48, v48
    v_exp_f32 v49, v49
    v_exp_f32 v50, v50
    v_exp_f32 v51, v51
    v_mfma_f32_32x32x16_bf16 v[16:31], v[92:95], v[68:71], v[16:31]
    ds_read_b128 v[84:87], v4 offset:13312
    v_cvt_pk_bf16_f32 v64, v48, v49
    v_cvt_pk_bf16_f32 v65, v50, v51
    v_exp_f32 v52, v52
    v_exp_f32 v53, v53
    v_exp_f32 v54, v54
    v_exp_f32 v55, v55
    v_mfma_f32_32x32x16_bf16 v[32:47], v[76:79], v[12:15], v[32:47]
    ds_read_b128 v[88:91], v4 offset:10240
    v_cvt_pk_bf16_f32 v66, v52, v53
    v_cvt_pk_bf16_f32 v67, v54, v55
    v_exp_f32 v56, v56
    v_exp_f32 v57, v57
    v_exp_f32 v58, v58
    v_exp_f32 v59, v59
    v_mfma_f32_32x32x16_bf16 v[16:31], v[96:99], v[64:67], v[16:31]
    ds_read_b128 v[92:95], v4 offset:11264
    v_cvt_pk_bf16_f32 v68, v56, v57
    v_cvt_pk_bf16_f32 v69, v58, v59
    v_exp_f32 v60, v60
    v_exp_f32 v61, v61
    v_exp_f32 v62, v62
    v_exp_f32 v63, v63
    s_setprio 2
    s_waitcnt vmcnt(0) lgkmcnt(1)
    v_cvt_pk_bf16_f32 v70, v60, v61
    v_cvt_pk_bf16_f32 v71, v62, v63
    v_mfma_f32_32x32x16_bf16 v[48:63], v[80:83], v[8:11], 0
    s_barrier
    ds_read_b128 v[72:75], v5 offset:0
    v_exp_f32 v32, v32
    v_exp_f32 v33, v33
    v_exp_f32 v34, v34
    v_exp_f32 v35, v35
    v_mfma_f32_32x32x16_bf16 v[16:31], v[100:103], v[68:71], v[16:31]
    ds_read_b128 v[76:79], v5 offset:1024
    v_cvt_pk_bf16_f32 v64, v32, v33
    v_cvt_pk_bf16_f32 v65, v34, v35
    v_exp_f32 v36, v36
    v_exp_f32 v37, v37
    v_exp_f32 v38, v38
    v_exp_f32 v39, v39
    v_mfma_f32_32x32x16_bf16 v[48:63], v[84:87], v[12:15], v[48:63]
    ds_read_b128 v[96:99], v4 offset:14336
    v_cvt_pk_bf16_f32 v66, v36, v37
    v_cvt_pk_bf16_f32 v67, v38, v39
    v_exp_f32 v40, v40
    v_exp_f32 v41, v41
    v_exp_f32 v42, v42
    v_exp_f32 v43, v43
    v_mfma_f32_32x32x16_bf16 v[16:31], v[88:91], v[64:67], v[16:31]
    ds_read_b128 v[100:103], v4 offset:15360
    v_cvt_pk_bf16_f32 v68, v40, v41
    v_cvt_pk_bf16_f32 v69, v42, v43
    v_exp_f32 v44, v44
    v_exp_f32 v45, v45
    v_exp_f32 v46, v46
    v_exp_f32 v47, v47
    s_setprio 1
    s_waitcnt lgkmcnt(1)
    v_cvt_pk_bf16_f32 v70, v44, v45
    v_cvt_pk_bf16_f32 v71, v46, v47
    v_mfma_f32_32x32x16_bf16 v[32:47], v[72:75], v[8:11], 0
    ds_read_b128 v[80:83], v5 offset:4096
    v_exp_f32 v48, v48
    v_exp_f32 v49, v49
    v_exp_f32 v50, v50
    v_exp_f32 v51, v51
    v_mfma_f32_32x32x16_bf16 v[16:31], v[92:95], v[68:71], v[16:31]
    ds_read_b128 v[84:87], v5 offset:5120
    v_cvt_pk_bf16_f32 v64, v48, v49
    v_cvt_pk_bf16_f32 v65, v50, v51
    v_exp_f32 v52, v52
    v_exp_f32 v53, v53
    v_exp_f32 v54, v54
    v_exp_f32 v55, v55
    v_mfma_f32_32x32x16_bf16 v[32:47], v[76:79], v[12:15], v[32:47]
    ds_read_b128 v[88:91], v5 offset:2048
    v_cvt_pk_bf16_f32 v66, v52, v53
    v_cvt_pk_bf16_f32 v67, v54, v55
    v_exp_f32 v56, v56
    v_exp_f32 v57, v57
    v_exp_f32 v58, v58
    v_exp_f32 v59, v59
    v_mfma_f32_32x32x16_bf16 v[16:31], v[96:99], v[64:67], v[16:31]
    ds_read_b128 v[92:95], v5 offset:3072
    s_add_u32 s11, s11, 32768
    s_cmp_eq_u32 s11, 98304
    s_cselect_b32 s11, 0, s11
    s_add_u32 s12, s11, s36
    s_add_u32 s10, s10, 1
    s_cmp_lt_u32 s10, 8
    v_mov_b32 v4, v5
    v_add_u32 v5, s12, v3
    v_cvt_pk_bf16_f32 v68, v56, v57
    v_cvt_pk_bf16_f32 v69, v58, v59
    v_exp_f32 v60, v60
    v_exp_f32 v61, v61
    v_exp_f32 v62, v62
    v_exp_f32 v63, v63
    s_cbranch_scc1 A_loop
    s_waitcnt lgkmcnt(0)
    v_cvt_pk_bf16_f32 v70, v60, v61
    v_cvt_pk_bf16_f32 v71, v62, v63
    s_nop 1
    v_mfma_f32_32x32x16_bf16 v[16:31], v[100:103], v[68:71], v[16:31]
    s_setprio 3
    s_lshl_b32 s13, s6, 12
    v_add_u32 v6, s13, v3
    s_lshl_b32 s13, s6, 8
    v_lshl_add_u32 v104, v2, 2, s13
    s_lshl_b32 s37, s46, 16
    s_lshl_b32 s13, s6, 11
    s_lshl_b32 s12, s5, 10
    s_add_u32 s35, s35, s12
    s_add_u32 s13, s13, s12
    s_add_u32 s13, s13, 32768
    v_add_u32 v7, s13, v3
    s_mov_b32 s14, 0
    s_mov_b32 s15, 0x5d800000
    s_cmp_eq_u32 s5, 0
    s_cbranch_scc1 A_g0
    ds_write_b128 v6, v[16:19]
    ds_write_b128 v6, v[20:23] offset:1024
    ds_write_b32 v104, v31 offset:16384
    s_getreg_b32 s38, hwreg(HW_REG_XCC_ID, 0, 4)
    s_add_u32 s38, s38, 1
    s_xor_b32 s38, s38, s46
    v_xor_b32 v108, s38, v108
    v_xor_b32 v109, s38, v109
    v_xor_b32 v110, s38, v110
    v_xor_b32 v111, s38, v111
    v_or3_b32 v108, v108, v109, v110
    v_or_b32 v108, v108, v111
    s_nop 0
    v_readfirstlane_b32 s39, v108
    s_nop 0
    s_cmp_eq_u32 s39, 0
    s_cselect_b32 s39, 1, 0
    s_waitcnt lgkmcnt(0)
    s_barrier
    ds_read_b128 v[36:39], v6 offset:3072
    ds_read_b128 v[32:35], v6 offset:2048
    s_waitcnt lgkmcnt(1)
    v_pk_add_f32 v[30:31], v[30:31], v[38:39]
    v_pk_add_f32 v[28:29], v[28:29], v[36:37]
    s_waitcnt lgkmcnt(0)
    v_pk_add_f32 v[24:25], v[24:25], v[32:33]
    v_pk_add_f32 v[26:27], v[26:27], v[34:35]
A_norm1:
    s_nop 5
    v_rcp_f32 v42, v31
    s_cmp_lg_u32 s14, 0
    s_cbranch_scc1 A_store1
    v_pk_mul_f32 v[44:45], v[24:25], 0 op_sel_hi:[1,0]
    v_pk_fma_f32 v[44:45], v[26:27], 0, v[44:45] op_sel_hi:[1,0,1]
    v_pk_fma_f32 v[44:45], v[28:29], 0, v[44:45] op_sel_hi:[1,0,1]
    v_pk_fma_f32 v[44:45], v[30:31], 0, v[44:45] op_sel_hi:[1,0,1]
    v_add_f32 v44, v44, v31
    v_add_f32 v43, v44, v45
    v_cmp_le_f32 vcc, 0x21800000, v43
    v_cmp_ge_f32 s[22:23], s15, v43
    s_nop 0
    s_and_b64 vcc, vcc, s[22:23]
    s_cmp_eq_u64 vcc, exec
    s_cbranch_scc0 A_slow
A_store1:
    v_pk_mul_f32 v[24:25], v[24:25], v[42:43] op_sel_hi:[1,0]
    v_pk_mul_f32 v[26:27], v[26:27], v[42:43] op_sel_hi:[1,0]
    v_pk_mul_f32 v[28:29], v[28:29], v[42:43] op_sel_hi:[1,0]
    v_mul_f32 v30, v30, v42
    v_cvt_pk_bf16_f32 v64, v24, v25
    v_cvt_pk_bf16_f32 v65, v26, v27
    v_cvt_pk_bf16_f32 v66, v28, v29
    v_cvt_pk_bf16_f32 v68, v30, 0
    v_or_b32 v67, s37, v68
    s_branch A_pub
A_g0:
    ds_write_b128 v6, v[24:27] offset:2048
    ds_write_b128 v6, v[28:31] offset:3072
    s_getreg_b32 s38, hwreg(HW_REG_XCC_ID, 0, 4)
    s_add_u32 s38, s38, 1
    s_xor_b32 s38, s38, s46
    v_xor_b32 v108, s38, v108
    v_xor_b32 v109, s38, v109
    v_xor_b32 v110, s38, v110
    v_xor_b32 v111, s38, v111
    v_or3_b32 v108, v108, v109, v110
    v_or_b32 v108, v108, v111
    s_nop 0
    v_readfirstlane_b32 s39, v108
    s_nop 0
    s_cmp_eq_u32 s39, 0
    s_cselect_b32 s39, 1, 0
    s_waitcnt lgkmcnt(0)
    s_barrier
    ds_read_b32 v41, v104 offset:16384
    ds_read_b128 v[36:39], v6 offset:1024
    ds_read_b128 v[32:35], v6 offset:0
    s_waitcnt lgkmcnt(1)
    v_add_f32 v31, v31, v41
    v_pk_add_f32 v[22:23], v[22:23], v[38:39]
    v_pk_add_f32 v[20:21], v[20:21], v[36:37]
    s_waitcnt lgkmcnt(0)
    v_pk_add_f32 v[16:17], v[16:17], v[32:33]
    v_pk_add_f32 v[18:19], v[18:19], v[34:35]
A_norm0:
    s_nop 6
    v_rcp_f32 v42, v31
    s_cmp_lg_u32 s14, 0
    s_cbranch_scc1 A_store0
    v_pk_mul_f32 v[44:45], v[16:17], 0 op_sel_hi:[1,0]
    v_pk_fma_f32 v[44:45], v[18:19], 0, v[44:45] op_sel_hi:[1,0,1]
    v_pk_fma_f32 v[44:45], v[20:21], 0, v[44:45] op_sel_hi:[1,0,1]
    v_pk_fma_f32 v[44:45], v[22:23], 0, v[44:45] op_sel_hi:[1,0,1]
    v_add_f32 v44, v44, v31
    v_add_f32 v43, v44, v45
    v_cmp_le_f32 vcc, 0x21800000, v43
    v_cmp_ge_f32 s[22:23], s15, v43
    s_nop 0
    s_and_b64 vcc, vcc, s[22:23]
    s_cmp_eq_u64 vcc, exec
    s_cbranch_scc0 A_slow
A_store0:
    v_pk_mul_f32 v[16:17], v[16:17], v[42:43] op_sel_hi:[1,0]
    v_pk_mul_f32 v[18:19], v[18:19], v[42:43] op_sel_hi:[1,0]
    v_pk_mul_f32 v[20:21], v[20:21], v[42:43] op_sel_hi:[1,0]
    v_mul_f32 v22, v22, v42
    v_cvt_pk_bf16_f32 v64, v16, v17
    v_cvt_pk_bf16_f32 v65, v18, v19
    v_cvt_pk_bf16_f32 v66, v20, v21
    v_cvt_pk_bf16_f32 v68, v22, 0
    v_or_b32 v67, s37, v68
A_pub:
    s_cmp_eq_u32 s39, 1
    s_cbranch_scc1 A_stfast
    buffer_store_dwordx4 v[64:67], v3, s[56:59], s35 offen sc1
    s_branch A_stdone
A_stfast:
    buffer_store_dwordx4 v[64:67], v3, s[56:59], s35 offen
A_stdone:
    s_nop 1
    v_mov_b32 v67, v68
    ds_write_b128 v7, v[64:67]
    s_mul_i32 s13, s6, 6144
    s_lshl_b32 s12, s5, 10
    s_add_u32 s13, s13, s12
    s_add_u32 s13, s13, 40960
    v_add_u32 v7, s13, v3
    s_lshl_b32 s14, s44, 15
    s_add_u32 s14, s14, s12
    s_mul_i32 s12, s6, 3
    s_lshl_b32 s13, s45, 2
    s_add_u32 s12, s12, s13
    s_add_u32 s13, s12, 4
    s_and_b32 s13, s13, 15
    s_lshl_b32 s13, s13, 11
    s_add_u32 s16, s13, s14
    s_add_u32 s13, s12, 5
    s_and_b32 s13, s13, 15
    s_lshl_b32 s13, s13, 11
    s_add_u32 s17, s13, s14
    s_add_u32 s13, s12, 6
    s_and_b32 s13, s13, 15
    s_lshl_b32 s13, s13, 11
    s_add_u32 s18, s13, s14
    s_waitcnt lgkmcnt(0)
    s_barrier
    s_cmp_eq_u32 s39, 1
    s_cbranch_scc1 A_gfast
    s_sleep 12
A_gfast:
    s_mov_b32 s47, 0
A_gath:
    buffer_load_dwordx4 v[32:35], v3, s[56:59], s16 offen sc1
    buffer_load_dwordx4 v[36:39], v3, s[56:59], s17 offen sc1
    buffer_load_dwordx4 v[40:43], v3, s[56:59], s18 offen sc1
    s_add_u32 s47, s47, 1
    s_waitcnt vmcnt(2)
    v_xor_b32 v35, s37, v35
    s_waitcnt vmcnt(1)
    v_xor_b32 v39, s37, v39
    s_waitcnt vmcnt(0)
    v_xor_b32 v43, s37, v43
    v_or3_b32 v8, v35, v39, v43
    v_cmp_lt_u32 vcc, 0xffff, v8
    s_cbranch_vccz A_gok
    s_cmp_lt_u32 s47, 400000
    s_sleep 3
    s_cbranch_scc1 A_gath
A_gok:
    ds_write_b128 v7, v[32:35] offset:0
    ds_write_b128 v7, v[36:39] offset:2048
    ds_write_b128 v7, v[40:43] offset:4096
    s_waitcnt lgkmcnt(0)
    s_barrier
    s_endpgm
A_slow:
    s_mov_b32 s14, 1
    v_mov_b32 v45, 0xff800000
    s_mov_b32 s13, 0
A_slow1:
    buffer_load_dwordx4 v[72:75], v3, s[52:55], s13 offen sc1
    buffer_load_dwordx4 v[76:79], v3, s[52:55], s13 offen offset:1024 sc1
    s_waitcnt vmcnt(0)
    v_mfma_f32_32x32x16_bf16 v[48:63], v[72:75], v[8:11], 0
    v_mfma_f32_32x32x16_bf16 v[48:63], v[76:79], v[12:15], v[48:63]
    s_nop 11
    v_max3_f32 v45, v45, v48, v49
    v_max3_f32 v45, v45, v50, v51
    v_max3_f32 v45, v45, v52, v53
    v_max3_f32 v45, v45, v54, v55
    v_max3_f32 v45, v45, v56, v57
    v_max3_f32 v45, v45, v58, v59
    v_max3_f32 v45, v45, v60, v61
    v_max3_f32 v45, v45, v62, v63
    s_add_u32 s13, s13, 4096
    s_cmp_lt_u32 s13, 262144
    s_cbranch_scc1 A_slow1
    v_mov_b32 v46, v45
    s_nop 1
    v_permlane32_swap_b32 v45, v46
    v_max_f32 v45, v45, v46
    v_sub_f32 v45, 0, v45
    v_and_b32 v46, 0xffff0000, v45
    v_sub_f32 v45, v45, v46
    v_and_b32 v47, 0xffff0000, v45
    v_sub_f32 v45, v45, v47
    v_lshrrev_b32 v46, 16, v46
    v_or_b32 v46, v46, v47
    v_lshrrev_b32 v45, 16, v45
    s_mov_b32 exec_lo, 0x0
    s_mov_b32 exec_hi, 0xffffffff
    v_mov_b32 v14, v46
    v_mov_b32 v15, v45
    s_mov_b32 exec_lo, 0xffffffff
    s_mov_b32 exec_hi, 0xffffffff
    v_mov_b32 v16, 0
    v_mov_b32 v17, 0
    v_mov_b32 v18, 0
    v_mov_b32 v19, 0
    v_mov_b32 v20, 0
    v_mov_b32 v21, 0
    v_mov_b32 v22, 0
    v_mov_b32 v23, 0
    v_mov_b32 v24, 0
    v_mov_b32 v25, 0
    v_mov_b32 v26, 0
    v_mov_b32 v27, 0
    v_mov_b32 v28, 0
    v_mov_b32 v29, 0
    v_mov_b32 v30, 0
    v_mov_b32 v31, 0
    s_mov_b32 s13, 0
A_slow2:
    buffer_load_dwordx4 v[72:75], v3, s[52:55], s13 offen offset:0 sc1
    buffer_load_dwordx4 v[76:79], v3, s[52:55], s13 offen offset:1024 sc1
    buffer_load_dwordx4 v[80:83], v3, s[52:55], s13 offen offset:2048 sc1
    buffer_load_dwordx4 v[84:87], v3, s[52:55], s13 offen offset:3072 sc1
    s_waitcnt vmcnt(0)
    v_mfma_f32_32x32x16_bf16 v[48:63], v[72:75], v[8:11], 0
    v_mfma_f32_32x32x16_bf16 v[48:63], v[76:79], v[12:15], v[48:63]
    s_nop 11
    v_exp_f32 v48, v48
    v_exp_f32 v49, v49
    v_exp_f32 v50, v50
    v_exp_f32 v51, v51
    v_cvt_pk_bf16_f32 v64, v48, v49
    v_cvt_pk_bf16_f32 v65, v50, v51
    v_exp_f32 v52, v52
    v_exp_f32 v53, v53
    v_exp_f32 v54, v54
    v_exp_f32 v55, v55
    v_cvt_pk_bf16_f32 v66, v52, v53
    v_cvt_pk_bf16_f32 v67, v54, v55
    v_exp_f32 v56, v56
    v_exp_f32 v57, v57
    v_exp_f32 v58, v58
    v_exp_f32 v59, v59
    v_cvt_pk_bf16_f32 v68, v56, v57
    v_cvt_pk_bf16_f32 v69, v58, v59
    v_exp_f32 v60, v60
    v_exp_f32 v61, v61
    v_exp_f32 v62, v62
    v_exp_f32 v63, v63
    v_cvt_pk_bf16_f32 v70, v60, v61
    v_cvt_pk_bf16_f32 v71, v62, v63
    v_mfma_f32_32x32x16_bf16 v[16:31], v[80:83], v[64:67], v[16:31]
    s_nop 0
    v_mfma_f32_32x32x16_bf16 v[16:31], v[84:87], v[68:71], v[16:31]
    s_add_u32 s13, s13, 4096
    s_cmp_lt_u32 s13, 262144
    s_cbranch_scc1 A_slow2
    s_cmp_eq_u32 s5, 0
    s_cbranch_scc1 A_norm0
    s_branch A_norm1
F_P:
    s_setprio 3
    s_sub_u32 s4, s3, 8
    s_lshr_b32 s5, s4, 1
    s_and_b32 s6, s4, 1
    s_lshl_b32 s10, s4, 2
    s_add_u32 s11, s10, 0
    s_and_b32 s11, s11, 7
    s_lshl_b32 s11, s11, 4
    v_xor_b32 v44, s11, v3
    s_add_u32 s11, s10, 1
    s_and_b32 s11, s11, 7
    s_lshl_b32 s11, s11, 4
    v_xor_b32 v45, s11, v3
    s_add_u32 s11, s10, 2
    s_and_b32 s11, s11, 7
    s_lshl_b32 s11, s11, 4
    v_xor_b32 v46, s11, v3
    s_add_u32 s11, s10, 3
    s_and_b32 s11, s11, 7
    s_lshl_b32 s11, s11, 4
    v_xor_b32 v47, s11, v3
    v_mov_b32 v40, 161280
    v_lshrrev_b32 v4, 3, v2
    v_mul_u32_u24 v4, 896, v4
    v_and_b32 v5, 7, v2
    v_lshl_add_u32 v4, v5, 4, v4
    s_sub_u32 s47, s9, 2
    s_lshl_b32 s14, s47, 2
    s_add_u32 s14, s14, s4
    s_mul_i32 s14, s14, 14336
    s_lshl_b32 s11, s7, 7
    s_add_u32 s14, s14, s11
    s_lshl_b32 s15, s4, 11
    s_lshr_b32 s13, s9, 1
    s_lshl_b32 s13, s13, 2
    s_add_u32 s13, s13, s4
    s_lshl_b32 s13, s13, 9
    v_lshlrev_b32 v5, 7, v2
    s_lshl_b32 s10, s44, 2
    s_add_u32 s10, s10, s4
    s_mul_i32 s10, s10, 7168
    s_mul_i32 s12, s4, 7168
    s_add_u32 s11, s12, 69632
    s_barrier
    s_waitcnt lgkmcnt(0)
    s_mov_b32 s20, s30
    s_mov_b32 s21, s31
    s_mov_b32 s22, 0x1c0000
    s_mov_b32 s23, 0x20000
    s_bitcmp1_b32 s45, 0
    s_cselect_b32 s24, s36, s34
    s_cselect_b32 s25, s37, s35
    s_mov_b32 s26, 25088
    s_mov_b32 s27, 0x20000
    s_cmp_lg_u32 s4, 0
    s_cselect_b32 s35, 1, 0
    s_cmp_eq_u32 s7, 7
    s_cselect_b32 s34, 3, 2
    s_cmp_ge_u32 s45, 2
    s_cselect_b32 s35, s34, s35
    s_cmp_lg_u32 s35, 2
    s_cbranch_scc1 P_ld_nou
    s_mov_b32 s18, 1835008
    s_mov_b32 s19, 0x20000
    s_add_u32 m0, s15, 98304
    s_add_u32 s47, s14, 0
    buffer_load_dwordx4 v4, s[16:19], s47 offen nt lds
    s_add_u32 m0, s15, 99328
    s_add_u32 s47, s14, 7168
    buffer_load_dwordx4 v4, s[16:19], s47 offen nt lds
    s_add_u32 m0, s15, 106496
    s_add_u32 s47, s14, 114688
    buffer_load_dwordx4 v4, s[16:19], s47 offen nt lds
    s_add_u32 m0, s15, 107520
    s_add_u32 s47, s14, 121856
    buffer_load_dwordx4 v4, s[16:19], s47 offen nt lds
P_ld_nou:
    s_mov_b64 exec, 15
    buffer_load_dword v33, v5, s[24:27], s13 offen
    s_mov_b32 exec_lo, -1
    s_mov_b32 exec_hi, 0xffffff
    s_add_u32 m0, s11, 0
    s_nop 0
    buffer_load_dwordx4 v44, s[20:23], s10 offen nt lds
    s_add_u32 s10, s10, 896
    s_add_u32 m0, s11, 896
    s_nop 0
    buffer_load_dwordx4 v44, s[20:23], s10 offen nt lds
    s_add_u32 s10, s10, 896
    s_add_u32 m0, s11, 1792
    s_nop 0
    buffer_load_dwordx4 v45, s[20:23], s10 offen nt lds
    s_add_u32 s10, s10, 896
    s_add_u32 m0, s11, 2688
    s_nop 0
    buffer_load_dwordx4 v45, s[20:23], s10 offen nt lds
    s_add_u32 s10, s10, 896
    s_add_u32 m0, s11, 3584
    s_nop 0
    buffer_load_dwordx4 v46, s[20:23], s10 offen nt lds
    s_add_u32 s10, s10, 896
    s_add_u32 m0, s11, 4480
    s_nop 0
    buffer_load_dwordx4 v46, s[20:23], s10 offen nt lds
    s_add_u32 s10, s10, 896
    s_add_u32 m0, s11, 5376
    s_nop 0
    buffer_load_dwordx4 v47, s[20:23], s10 offen nt lds
    s_add_u32 s10, s10, 896
    s_add_u32 m0, s11, 6272
    s_nop 0
    buffer_load_dwordx4 v47, s[20:23], s10 offen nt lds
    s_mov_b32 exec_hi, -1
    s_cmp_ge_u32 s45, 2
    s_cbranch_scc1 P_ld_nokv
    s_add_u32 m0, s12, 98304
    s_add_u32 s10, s12, 0
    buffer_load_dwordx4 v3, s[24:27], s10 offen offset:0 lds
    buffer_load_dwordx4 v3, s[24:27], s10 offen offset:1024 lds
    buffer_load_dwordx4 v3, s[24:27], s10 offen offset:2048 lds
    buffer_load_dwordx4 v3, s[24:27], s10 offen offset:3072 lds
    s_add_u32 m0, s12, 102400
    s_add_u32 s10, s12, 4096
    buffer_load_dwordx4 v3, s[24:27], s10 offen offset:0 lds
    buffer_load_dwordx4 v3, s[24:27], s10 offen offset:1024 lds
    buffer_load_dwordx4 v3, s[24:27], s10 offen offset:2048 lds
P_ld_nokv:
    s_add_u32 s48, s42, 0xc20000
    s_addc_u32 s49, s43, 0
    s_load_dword s46, s[48:49], 0
    s_mov_b32 s50, 0x40000
    s_mov_b32 s51, 0x20000
    s_add_u32 s52, s42, 0x200000
    s_addc_u32 s53, s43, 0
    s_mov_b32 s54, 0x40000
    s_mov_b32 s55, 0x20000
    s_mov_b32 s20, s32
    s_mov_b32 s21, s33
    s_mov_b32 s22, 0x62000
    s_mov_b32 s23, 0x20000
    v_lshrrev_b32 v4, 2, v2
    v_mul_u32_u24 v4, 896, v4
    v_and_b32 v5, 3, v2
    v_lshl_add_u32 v4, v5, 4, v4
    s_lshl_b32 s13, s45, 2
    s_add_u32 s13, s13, s4
    s_mul_i32 s13, s13, 56
    s_lshr_b32 s14, s2, 5
    s_cmp_eq_u32 s14, 7
    s_cselect_b32 s14, 0, s14
    s_mov_b32 s34, s14
    s_lshl_b32 s32, s44, 12
    s_lshl_b32 s11, s45, 11
    s_add_u32 s32, s32, s11
    s_lshl_b32 s33, s44, 1
    s_add_u32 s33, s33, s45
    s_lshl_b32 s33, s33, 7
    s_add_u32 s33, s33, 16384
    v_mov_b32 v0, 0
    v_mov_b32 v41, 1
    v_and_b32 v6, 31, v2
    v_lshrrev_b32 v7, 5, v2
    v_bfe_u32 v42, v2, 1, 3
    v_mul_u32_u24 v43, 896, v6
    v_add_u32 v43, 69632, v43
    v_add_u32 v44, 0, v7
    v_xor_b32 v44, v44, v42
    v_lshl_add_u32 v44, v44, 4, v43
    v_add_u32 v45, 2, v7
    v_xor_b32 v45, v45, v42
    v_lshl_add_u32 v45, v45, 4, v43
    v_add_u32 v46, 4, v7
    v_xor_b32 v46, v46, v42
    v_lshl_add_u32 v46, v46, 4, v43
    v_add_u32 v47, 6, v7
    v_xor_b32 v47, v47, v42
    v_lshl_add_u32 v47, v47, 4, v43
    s_mul_i32 s10, s4, 5120
    s_add_u32 s10, s10, 140800
    v_add_u32 v48, s10, v3
    s_mov_b32 s15, s10
    v_bfe_u32 v42, v2, 2, 2
    v_lshl_add_u32 v42, v7, 3, v42
    v_and_b32 v43, 3, v2
    v_lshlrev_b32 v43, 3, v43
    v_and_b32 v51, 16, v2
    v_lshl_add_u32 v43, v51, 1, v43
    v_lshl_add_u32 v49, v42, 6, v43
    v_add_u32 v49, s10, v49
    v_mul_u32_u24 v50, 56, v42
    s_add_u32 s11, s12, 98304
    v_add3_u32 v50, v50, v43, s11
    v_add_u32 v42, s11, v3
    s_lshl_b32 s10, s4, 8
    v_add_u32 v52, s10, v44
    v_add_u32 v53, s10, v45
    v_add_u32 v54, s10, v46
    v_add_u32 v55, s10, v47
    v_cmp_le_u32 vcc, 11, v6
    s_nop 1
    v_addc_co_u32 v43, vcc, 0, v6, vcc
    v_cmp_le_u32 vcc, 14, v6
    s_nop 1
    v_addc_co_u32 v43, vcc, 0, v43, vcc
    v_cmp_le_u32 vcc, 25, v6
    s_nop 1
    v_addc_co_u32 v43, vcc, 0, v43, vcc
    v_mov_b32 v51, 11
    v_cmp_eq_u32 vcc, 28, v6
    s_nop 1
    v_cndmask_b32 v43, v43, v51, vcc
    v_mov_b32 v51, 15
    v_cmp_eq_u32 vcc, 29, v6
    s_nop 1
    v_cndmask_b32 v43, v43, v51, vcc
    v_mov_b32 v51, 27
    v_cmp_eq_u32 vcc, 30, v6
    s_nop 1
    v_cndmask_b32 v43, v43, v51, vcc
    v_mov_b32 v51, 31
    v_cmp_eq_u32 vcc, 31, v6
    s_nop 1
    v_cndmask_b32 v43, v43, v51, vcc
    v_and_b32 v51, 32, v2
    v_add_lshl_u32 v43, v43, v51, 4
    s_cmp_eq_u32 s45, 1
    s_cselect_b64 vcc, -1, 0
    v_cndmask_b32 v43, v3, v43, vcc
    s_add_u32 s56, s42, 0x8a0000
    s_addc_u32 s57, s43, 0
    s_mov_b32 s58, 0x1c0000
    s_mov_b32 s59, 0x20000
    s_add_u32 s60, s42, 0xa60000
    s_addc_u32 s61, s43, 0
    s_mov_b32 s62, 0x1c0000
    s_mov_b32 s63, 0x20000
    s_mov_b32 s30, s15
    s_mov_b32 s28, s38
    s_mov_b32 s29, s39
    s_mov_b32 s36, s40
    s_mov_b32 s37, s41
    s_mov_b32 s38, 3670016
    s_mov_b32 s39, 0x20000
    s_waitcnt lgkmcnt(0)
    s_mul_i32 s46, s46, 0x9E3779B1
    s_add_u32 s46, s46, 0x7F4A7C15
    v_mov_b32 v1, s46
    s_getreg_b32 s10, hwreg(HW_REG_XCC_ID, 0, 4)
    s_add_u32 s10, s10, 1
    s_xor_b32 s10, s10, s46
    v_mov_b32 v7, s10
    v_and_b32 v20, 15, v2
    v_lshrrev_b32 v21, 4, v2
    v_bfe_u32 v22, v2, 2, 2
    v_lshl_add_u32 v22, v21, 3, v22
    v_lshlrev_b32 v22, 7, v22
    v_and_b32 v23, 3, v2
    v_lshl_add_u32 v22, v23, 3, v22
    s_lshl_b32 s10, s4, 5
    s_add_u32 s10, s10, 98304
    v_add_u32 v5, s10, v22
    v_lshlrev_b32 v6, 12, v20
    v_lshl_add_u32 v6, v21, 4, v6
    s_lshl_b32 s10, s7, 18
    s_lshl_b32 s11, s4, 16
    s_add_u32 s10, s10, s11
    s_sub_u32 s17, s9, 2
    s_lshl_b32 s11, s17, 7
    s_add_u32 s16, s10, s11
    s_lshl_b32 s10, s7, 13
    s_lshl_b32 s11, s4, 11
    s_add_u32 s10, s10, s11
    s_lshl_b32 s11, s17, 6
    s_add_u32 s10, s10, s11
    s_add_u32 s17, s10, 32768
    s_cmp_lg_u32 s35, 0
    s_cbranch_scc1 P_ld_w0
    buffer_load_dwordx4 v[24:27], v3, s[52:55], s32 offen sc1
    buffer_load_dwordx4 v[28:31], v3, s[52:55], s32 offen offset:1024 sc1
    buffer_load_dword v32, v0, s[48:51], s33 offen sc1
P_ld_w0:
    s_cmp_lt_u32 s35, 2
    s_cbranch_scc1 P_nou2
    s_cmp_eq_u32 s35, 3
    s_cbranch_scc1 P_nou
    s_waitcnt vmcnt(9)
    s_mov_b64 exec, 1
    ds_add_u32 v40, v41 offset:4
    s_mov_b64 exec, -1
    s_mov_b32 s47, 0
PUL_spin:
    ds_read_b32 v51, v40 offset:4
    s_add_u32 s47, s47, 1
    s_waitcnt lgkmcnt(0)
    v_readfirstlane_b32 s15, v51
    s_nop 0
    s_cmp_ge_u32 s15, 4
    s_cbranch_scc1 PUL_go
    s_cmp_lt_u32 s47, 2000000
    s_cbranch_scc1 PUL_spin
PUL_go:
    ds_read_b64_tr_b16 v[96:97], v5 offset:0
    ds_read_b64_tr_b16 v[98:99], v5 offset:512
    ds_read_b64_tr_b16 v[100:101], v5 offset:4096
    ds_read_b64_tr_b16 v[102:103], v5 offset:4608
    ds_read_b64_tr_b16 v[104:105], v5 offset:8192
    ds_read_b64_tr_b16 v[106:107], v5 offset:8704
    ds_read_b64_tr_b16 v[108:109], v5 offset:12288
    ds_read_b64_tr_b16 v[110:111], v5 offset:12800
    s_waitcnt lgkmcnt(6)
    buffer_store_dwordx4 v[96:99], v6, s[56:59], s16 offen offset:0 sc1
    s_waitcnt lgkmcnt(4)
    buffer_store_dwordx4 v[100:103], v6, s[56:59], s16 offen offset:64 sc1
    s_waitcnt lgkmcnt(2)
    buffer_store_dwordx4 v[104:107], v6, s[56:59], s16 offen offset:256 sc1
    s_waitcnt lgkmcnt(0)
    buffer_store_dwordx4 v[108:111], v6, s[56:59], s16 offen offset:320 sc1
P_nou:
    s_mov_b64 exec, 1
    ds_add_u32 v40, v41 offset:44
    s_mov_b64 exec, -1
    s_waitcnt vmcnt(4)
    s_cmp_eq_u32 s35, 2
    s_cbranch_scc1 P_xw
P_nou2:
    s_waitcnt vmcnt(3)
    s_cmp_eq_u32 s35, 0
    s_cbranch_scc1 P_xw
    s_waitcnt vmcnt(0)
P_xw:
    s_mov_b64 exec, 1
    ds_add_u32 v40, v41 offset:0
    s_mov_b64 exec, -1
    s_mov_b32 s47, 0
PX_spin:
    ds_read_b32 v51, v40 offset:0
    s_add_u32 s47, s47, 1
    s_waitcnt lgkmcnt(0)
    v_readfirstlane_b32 s15, v51
    s_nop 0
    s_cmp_ge_u32 s15, 4
    s_cbranch_scc1 PX_go
    s_cmp_lt_u32 s47, 2000000
    s_cbranch_scc1 PX_spin
PX_go:
    s_cmp_ge_u32 s35, 2
    s_cbranch_scc1 P_nokv
    s_cmp_eq_u32 s4, 3
    s_cbranch_scc1 P_kv4
    ds_read_b64_tr_b16 v[104:105], v50 offset:0
    ds_read_b64_tr_b16 v[106:107], v50 offset:224
    ds_read_b128 v[108:111], v52 offset:0
    ds_read_b64_tr_b16 v[112:113], v50 offset:896
    ds_read_b64_tr_b16 v[114:115], v50 offset:1120
    ds_read_b128 v[116:119], v53 offset:0
    ds_read_b64_tr_b16 v[120:121], v50 offset:1792
    ds_read_b64_tr_b16 v[122:123], v50 offset:2016
    ds_read_b128 v[124:127], v54 offset:0
    ds_read_b64_tr_b16 v[128:129], v50 offset:2688
    ds_read_b64_tr_b16 v[130:131], v50 offset:2912
    ds_read_b128 v[132:135], v55 offset:0
    ds_read_b64_tr_b16 v[136:137], v50 offset:3584
    ds_read_b64_tr_b16 v[138:139], v50 offset:3808
    ds_read_b128 v[140:143], v52 offset:128
    ds_read_b64_tr_b16 v[144:145], v50 offset:4480
    ds_read_b64_tr_b16 v[146:147], v50 offset:4704
    ds_read_b128 v[148:151], v53 offset:128
    ds_read_b64_tr_b16 v[152:153], v50 offset:5376
    ds_read_b64_tr_b16 v[154:155], v50 offset:5600
    ds_read_b128 v[156:159], v54 offset:128
    ds_read_b64_tr_b16 v[160:161], v50 offset:6272
    ds_read_b64_tr_b16 v[162:163], v50 offset:6496
    ds_read_b128 v[164:167], v55 offset:128
    s_cmp_eq_u32 s45, 1
    s_cbranch_scc1 P_kvVa
    s_waitcnt lgkmcnt(15)
    v_mfma_f32_32x32x16_bf16 v[8:23], v[104:107], v[108:111], 0
    s_waitcnt lgkmcnt(15)
    v_mfma_f32_32x32x16_bf16 v[8:23], v[112:115], v[116:119], v[8:23]
    s_waitcnt lgkmcnt(15)
    v_mfma_f32_32x32x16_bf16 v[8:23], v[120:123], v[124:127], v[8:23]
    s_waitcnt lgkmcnt(12)
    v_mfma_f32_32x32x16_bf16 v[8:23], v[128:131], v[132:135], v[8:23]
    s_waitcnt lgkmcnt(9)
    v_mfma_f32_32x32x16_bf16 v[8:23], v[136:139], v[140:143], v[8:23]
    s_waitcnt lgkmcnt(6)
    v_mfma_f32_32x32x16_bf16 v[8:23], v[144:147], v[148:151], v[8:23]
    s_waitcnt lgkmcnt(3)
    v_mfma_f32_32x32x16_bf16 v[8:23], v[152:155], v[156:159], v[8:23]
    s_waitcnt lgkmcnt(0)
    v_mfma_f32_32x32x16_bf16 v[8:23], v[160:163], v[164:167], v[8:23]
    s_branch P_kvdone
P_kvVa:
    s_waitcnt lgkmcnt(15)
    v_mfma_f32_32x32x16_bf16 v[8:23], v[108:111], v[104:107], 0
    s_waitcnt lgkmcnt(15)
    v_mfma_f32_32x32x16_bf16 v[8:23], v[116:119], v[112:115], v[8:23]
    s_waitcnt lgkmcnt(15)
    v_mfma_f32_32x32x16_bf16 v[8:23], v[124:127], v[120:123], v[8:23]
    s_waitcnt lgkmcnt(12)
    v_mfma_f32_32x32x16_bf16 v[8:23], v[132:135], v[128:131], v[8:23]
    s_waitcnt lgkmcnt(9)
    v_mfma_f32_32x32x16_bf16 v[8:23], v[140:143], v[136:139], v[8:23]
    s_waitcnt lgkmcnt(6)
    v_mfma_f32_32x32x16_bf16 v[8:23], v[148:151], v[144:147], v[8:23]
    s_waitcnt lgkmcnt(3)
    v_mfma_f32_32x32x16_bf16 v[8:23], v[156:159], v[152:155], v[8:23]
    s_waitcnt lgkmcnt(0)
    v_mfma_f32_32x32x16_bf16 v[8:23], v[164:167], v[160:163], v[8:23]
    s_branch P_kvdone
P_kv4:
    ds_read_b64_tr_b16 v[104:105], v50 offset:0
    ds_read_b64_tr_b16 v[106:107], v50 offset:224
    ds_read_b128 v[108:111], v52 offset:0
    ds_read_b64_tr_b16 v[112:113], v50 offset:896
    ds_read_b64_tr_b16 v[114:115], v50 offset:1120
    ds_read_b128 v[116:119], v53 offset:0
    ds_read_b64_tr_b16 v[120:121], v50 offset:1792
    ds_read_b64_tr_b16 v[122:123], v50 offset:2016
    ds_read_b128 v[124:127], v54 offset:0
    ds_read_b64_tr_b16 v[128:129], v50 offset:2688
    ds_read_b64_tr_b16 v[130:131], v50 offset:2912
    ds_read_b128 v[132:135], v55 offset:0
    s_cmp_eq_u32 s45, 1
    s_cbranch_scc1 P_kvVb
    s_waitcnt lgkmcnt(9)
    v_mfma_f32_32x32x16_bf16 v[8:23], v[104:107], v[108:111], 0
    s_waitcnt lgkmcnt(6)
    v_mfma_f32_32x32x16_bf16 v[8:23], v[112:115], v[116:119], v[8:23]
    s_waitcnt lgkmcnt(3)
    v_mfma_f32_32x32x16_bf16 v[8:23], v[120:123], v[124:127], v[8:23]
    s_waitcnt lgkmcnt(0)
    v_mfma_f32_32x32x16_bf16 v[8:23], v[128:131], v[132:135], v[8:23]
    s_branch P_kvdone
P_kvVb:
    s_waitcnt lgkmcnt(9)
    v_mfma_f32_32x32x16_bf16 v[8:23], v[108:111], v[104:107], 0
    s_waitcnt lgkmcnt(6)
    v_mfma_f32_32x32x16_bf16 v[8:23], v[116:119], v[112:115], v[8:23]
    s_waitcnt lgkmcnt(3)
    v_mfma_f32_32x32x16_bf16 v[8:23], v[124:127], v[120:123], v[8:23]
    s_waitcnt lgkmcnt(0)
    v_mfma_f32_32x32x16_bf16 v[8:23], v[132:135], v[128:131], v[8:23]
P_kvdone:
    s_cmp_eq_u32 s35, 0
    s_cbranch_scc1 P_kv0
    s_nop 9
    ds_write_b128 v42, v[8:11] offset:0
    ds_write_b128 v42, v[12:15] offset:1024
    ds_write_b128 v42, v[16:19] offset:2048
    ds_write_b128 v42, v[20:23] offset:3072
    s_waitcnt lgkmcnt(0)
    s_mov_b64 exec, 1
    ds_add_u32 v40, v41 offset:4
    s_mov_b64 exec, -1
    s_branch P_rest
P_kv0:
    s_mul_i32 s31, s34, 57344
    s_add_u32 s31, s31, s13
    s_add_u32 s34, s34, 1
    s_cmp_eq_u32 s34, 7
    s_cselect_b32 s34, 0, s34
    s_add_u32 m0, s30, 0
    s_nop 0
    buffer_load_dwordx4 v4, s[20:23], s31 offen lds
    s_add_u32 s31, s31, 14336
    s_add_u32 m0, s30, 1024
    s_nop 0
    buffer_load_dwordx4 v4, s[20:23], s31 offen lds
    s_add_u32 s31, s31, 14336
    s_add_u32 m0, s30, 2048
    s_nop 0
    buffer_load_dwordx4 v4, s[20:23], s31 offen lds
    s_add_u32 s31, s31, 14336
    s_add_u32 m0, s30, 3072
    s_nop 0
    buffer_load_dwordx4 v4, s[20:23], s31 offen lds
    s_mul_i32 s31, s34, 57344
    s_add_u32 s31, s31, s13
    s_add_u32 s34, s34, 1
    s_cmp_eq_u32 s34, 7
    s_cselect_b32 s34, 0, s34
    s_add_u32 m0, s30, 4096
    s_nop 0
    buffer_load_dwordx4 v4, s[20:23], s31 offen lds
    s_mov_b32 s47, 0
PKV_spin:
    ds_read_b32 v51, v40 offset:4
    s_add_u32 s47, s47, 1
    s_waitcnt lgkmcnt(0)
    v_readfirstlane_b32 s15, v51
    s_nop 0
    s_cmp_ge_u32 s15, 3
    s_cbranch_scc1 PKV_go
    s_cmp_lt_u32 s47, 2000000
    s_cbranch_scc1 PKV_spin
PKV_go:
    ds_read_b128 v[104:107], v42 offset:7168
    ds_read_b128 v[108:111], v42 offset:8192
    ds_read_b128 v[112:115], v42 offset:9216
    ds_read_b128 v[116:119], v42 offset:10240
    ds_read_b128 v[120:123], v42 offset:14336
    ds_read_b128 v[124:127], v42 offset:15360
    ds_read_b128 v[128:131], v42 offset:16384
    ds_read_b128 v[132:135], v42 offset:17408
    ds_read_b128 v[136:139], v42 offset:21504
    ds_read_b128 v[140:143], v42 offset:22528
    ds_read_b128 v[144:147], v42 offset:23552
    ds_read_b128 v[148:151], v42 offset:24576
    s_waitcnt lgkmcnt(4)
    v_pk_add_f32 v[104:105], v[104:105], v[120:121]
    v_pk_add_f32 v[106:107], v[106:107], v[122:123]
    v_pk_add_f32 v[108:109], v[108:109], v[124:125]
    v_pk_add_f32 v[110:111], v[110:111], v[126:127]
    v_pk_add_f32 v[112:113], v[112:113], v[128:129]
    v_pk_add_f32 v[114:115], v[114:115], v[130:131]
    v_pk_add_f32 v[116:117], v[116:117], v[132:133]
    v_pk_add_f32 v[118:119], v[118:119], v[134:135]
    s_waitcnt lgkmcnt(0)
    v_pk_add_f32 v[8:9], v[8:9], v[136:137]
    v_pk_add_f32 v[10:11], v[10:11], v[138:139]
    v_pk_add_f32 v[12:13], v[12:13], v[140:141]
    v_pk_add_f32 v[14:15], v[14:15], v[142:143]
    v_pk_add_f32 v[16:17], v[16:17], v[144:145]
    v_pk_add_f32 v[18:19], v[18:19], v[146:147]
    v_pk_add_f32 v[20:21], v[20:21], v[148:149]
    v_pk_add_f32 v[22:23], v[22:23], v[150:151]
    v_pk_add_f32 v[8:9], v[8:9], v[104:105]
    v_pk_add_f32 v[10:11], v[10:11], v[106:107]
    v_pk_add_f32 v[12:13], v[12:13], v[108:109]
    v_pk_add_f32 v[14:15], v[14:15], v[110:111]
    v_pk_add_f32 v[16:17], v[16:17], v[112:113]
    v_pk_add_f32 v[18:19], v[18:19], v[114:115]
    v_pk_add_f32 v[20:21], v[20:21], v[116:117]
    v_pk_add_f32 v[22:23], v[22:23], v[118:119]
    s_waitcnt vmcnt(5)
    v_cvt_pk_bf16_f32 v24, v8, v9
    v_cvt_pk_bf16_f32 v25, v10, v11
    v_cvt_pk_bf16_f32 v26, v12, v13
    v_cvt_pk_bf16_f32 v27, v14, v15
    v_cvt_pk_bf16_f32 v28, v16, v17
    v_cvt_pk_bf16_f32 v29, v18, v19
    v_cvt_pk_bf16_f32 v30, v20, v21
    v_cvt_pk_bf16_f32 v31, v22, v23
    s_cmp_eq_u32 s45, 1
    s_cbranch_scc1 P_vfix
    s_mov_b32 exec_lo, 0x0
    s_mov_b32 exec_hi, 0xffffffff
    v_mov_b32 v30, 0x3f803f80
    v_mov_b32 v31, 0x3f80
    s_branch P_kvst
P_vfix:
    s_mov_b32 exec_lo, 0xc0000000
    s_mov_b32 exec_hi, 0xc0000000
    v_mov_b32 v24, 0x3f803f80
    v_mov_b32 v25, 0x3f803f80
    v_mov_b32 v26, 0x3f803f80
    v_mov_b32 v27, 0x3f803f80
    v_mov_b32 v28, 0x3f803f80
    v_mov_b32 v29, 0x3f803f80
    v_mov_b32 v30, 0x3f803f80
    v_mov_b32 v31, 0x3f803f80
    s_mov_b32 exec_lo, 0x30000000
    s_mov_b32 exec_hi, 0x30000000
    v_mov_b32 v24, 0
    v_mov_b32 v25, 0
    v_mov_b32 v26, 0
    v_mov_b32 v27, 0
    v_mov_b32 v28, 0
    v_mov_b32 v29, 0
    v_mov_b32 v30, 0
    v_mov_b32 v31, 0
P_kvst:
    s_mov_b64 exec, -1
    buffer_store_dwordx4 v[24:27], v43, s[52:55], s32 offen sc1
    buffer_store_dwordx4 v[28:31], v43, s[52:55], s32 offen offset:1024 sc1
    s_mov_b64 exec, 1
    ds_add_u32 v40, v41 offset:12
    s_mov_b64 exec, -1
    s_mov_b64 exec, 1
    ds_add_u32 v40, v41 offset:28
    s_mov_b64 exec, -1
    s_mov_b64 exec, 1
    ds_add_u32 v40, v41 offset:16
    s_mov_b64 exec, -1
    s_waitcnt vmcnt(0)
    s_mov_b64 exec, 1
    buffer_store_dword v1, v0, s[48:51], s33 offen sc1
    s_mov_b64 exec, -1
    s_branch P_pub
P_nokv:
    s_mul_i32 s31, s34, 57344
    s_add_u32 s31, s31, s13
    s_add_u32 s34, s34, 1
    s_cmp_eq_u32 s34, 7
    s_cselect_b32 s34, 0, s34
    s_add_u32 m0, s30, 0
    s_nop 0
    buffer_load_dwordx4 v4, s[20:23], s31 offen lds
    s_add_u32 s31, s31, 14336
    s_add_u32 m0, s30, 1024
    s_nop 0
    buffer_load_dwordx4 v4, s[20:23], s31 offen lds
    s_add_u32 s31, s31, 14336
    s_add_u32 m0, s30, 2048
    s_nop 0
    buffer_load_dwordx4 v4, s[20:23], s31 offen lds
    s_add_u32 s31, s31, 14336
    s_add_u32 m0, s30, 3072
    s_nop 0
    buffer_load_dwordx4 v4, s[20:23], s31 offen lds
    s_mul_i32 s31, s34, 57344
    s_add_u32 s31, s31, s13
    s_add_u32 s34, s34, 1
    s_cmp_eq_u32 s34, 7
    s_cselect_b32 s34, 0, s34
    s_add_u32 m0, s30, 4096
    s_nop 0
    buffer_load_dwordx4 v4, s[20:23], s31 offen lds
    s_cmp_lg_u32 s4, 0
    s_cbranch_scc1 P_nos2
    s_mov_b32 s47, 0
PUF_spin:
    ds_read_b32 v51, v40 offset:44
    s_add_u32 s47, s47, 1
    s_waitcnt lgkmcnt(0)
    v_readfirstlane_b32 s15, v51
    s_nop 0
    s_cmp_ge_u32 s15, 4
    s_cbranch_scc1 PUF_go
    s_cmp_lt_u32 s47, 2000000
    s_cbranch_scc1 PUF_spin
PUF_go:
    s_mov_b64 exec, 1
    ds_add_u32 v40, v41 offset:12
    s_mov_b64 exec, -1
    s_mov_b64 exec, 1
    ds_add_u32 v40, v41 offset:28
    s_mov_b64 exec, -1
    s_mov_b64 exec, 1
    ds_add_u32 v40, v41 offset:16
    s_mov_b64 exec, -1
P_nos2:
    s_cmp_eq_u32 s35, 3
    s_cbranch_scc1 P_pub
    s_waitcnt vmcnt(5)
    v_lshlrev_b32 v51, 7, v2
    s_mov_b64 exec, 3
    buffer_store_dword v1, v51, s[48:51], s17 offen sc1
    s_mov_b64 exec, -1
    s_branch P_pub
P_rest:
    s_mul_i32 s31, s34, 57344
    s_add_u32 s31, s31, s13
    s_add_u32 s34, s34, 1
    s_cmp_eq_u32 s34, 7
    s_cselect_b32 s34, 0, s34
    s_add_u32 m0, s30, 0
    s_nop 0
    buffer_load_dwordx4 v4, s[20:23], s31 offen lds
    s_add_u32 s31, s31, 14336
    s_add_u32 m0, s30, 1024
    s_nop 0
    buffer_load_dwordx4 v4, s[20:23], s31 offen lds
    s_add_u32 s31, s31, 14336
    s_add_u32 m0, s30, 2048
    s_nop 0
    buffer_load_dwordx4 v4, s[20:23], s31 offen lds
    s_add_u32 s31, s31, 14336
    s_add_u32 m0, s30, 3072
    s_nop 0
    buffer_load_dwordx4 v4, s[20:23], s31 offen lds
    s_mul_i32 s31, s34, 57344
    s_add_u32 s31, s31, s13
    s_add_u32 s34, s34, 1
    s_cmp_eq_u32 s34, 7
    s_cselect_b32 s34, 0, s34
    s_add_u32 m0, s30, 4096
    s_nop 0
    buffer_load_dwordx4 v4, s[20:23], s31 offen lds
P_pub:
    s_setprio 2
    s_cmp_lg_u32 s4, 0
    s_cbranch_scc1 P_nopf
    s_mov_b64 exec, 1
    ds_add_u32 v40, v41 offset:40
    s_mov_b64 exec, -1
P_nopf:
    s_cmp_lg_u32 s4, 1
    s_cbranch_scc1 P_nor
    s_lshl_b32 s11, s2, 2
    s_add_u32 s11, s11, 1024
    s_mov_b64 exec, 1
    buffer_store_dword v1, v0, s[48:51], s11 offen sc1
    s_mov_b64 exec, -1
    s_lshl_b32 s11, s44, 2
    s_add_u32 s11, s11, s45
    s_lshl_b32 s11, s11, 2
    s_add_u32 s11, s11, 2048
    s_mov_b64 exec, 1
    buffer_store_dword v7, v0, s[48:51], s11 offen sc1
    s_mov_b64 exec, -1
P_nor:
    s_lshl_b32 s10, s14, 7
    v_add_u32 v44, s10, v44
    v_add_u32 v45, s10, v45
    v_add_u32 v46, s10, v46
    v_add_u32 v47, s10, v47
    s_waitcnt vmcnt(4)
    ds_read_b64_tr_b16 v[24:25], v49 offset:0
    ds_read_b64_tr_b16 v[26:27], v49 offset:256
    ds_read_b128 v[28:31], v44
    s_waitcnt vmcnt(3)
    ds_read_b64_tr_b16 v[32:33], v49 offset:1024
    ds_read_b64_tr_b16 v[34:35], v49 offset:1280
    ds_read_b128 v[36:39], v45
    s_waitcnt lgkmcnt(3)
    v_mfma_f32_32x32x16_bf16 v[8:23], v[24:27], v[28:31], 0
    s_add_u32 s31, s31, 14336
    s_add_u32 m0, s30, 0
    s_nop 0
    buffer_load_dwordx4 v4, s[20:23], s31 offen lds
    s_waitcnt vmcnt(3)
    ds_read_b64_tr_b16 v[56:57], v49 offset:2048
    ds_read_b64_tr_b16 v[58:59], v49 offset:2304
    ds_read_b128 v[60:63], v46
    s_waitcnt lgkmcnt(3)
    v_mfma_f32_32x32x16_bf16 v[8:23], v[32:35], v[36:39], v[8:23]
    s_add_u32 s31, s31, 14336
    s_add_u32 m0, s30, 1024
    s_nop 0
    buffer_load_dwordx4 v4, s[20:23], s31 offen lds
    s_waitcnt vmcnt(3)
    ds_read_b64_tr_b16 v[24:25], v49 offset:3072
    ds_read_b64_tr_b16 v[26:27], v49 offset:3328
    ds_read_b128 v[28:31], v47
    s_waitcnt lgkmcnt(3)
    v_mfma_f32_32x32x16_bf16 v[8:23], v[56:59], v[60:63], v[8:23]
    s_add_u32 s31, s31, 14336
    s_add_u32 m0, s30, 2048
    s_nop 0
    buffer_load_dwordx4 v4, s[20:23], s31 offen lds
    s_add_u32 s14, s14, 1
    s_cmp_eq_u32 s14, 7
    s_cselect_b32 s10, -6, 1
    s_lshl_b32 s10, s10, 7
    v_add_u32 v44, s10, v44
    v_add_u32 v45, s10, v45
    v_add_u32 v46, s10, v46
    v_add_u32 v47, s10, v47
    s_waitcnt vmcnt(3)
    ds_read_b64_tr_b16 v[32:33], v49 offset:4096
    ds_read_b64_tr_b16 v[34:35], v49 offset:4352
    ds_read_b128 v[36:39], v44
    s_waitcnt lgkmcnt(3)
    v_mfma_f32_32x32x16_bf16 v[8:23], v[24:27], v[28:31], v[8:23]
    s_mul_i32 s31, s34, 57344
    s_add_u32 s31, s31, s13
    s_add_u32 s34, s34, 1
    s_cmp_eq_u32 s34, 7
    s_cselect_b32 s34, 0, s34
    s_add_u32 m0, s30, 3072
    s_nop 0
    buffer_load_dwordx4 v4, s[20:23], s31 offen lds
    s_waitcnt vmcnt(3)
    ds_read_b64_tr_b16 v[56:57], v49 offset:0
    ds_read_b64_tr_b16 v[58:59], v49 offset:256
    ds_read_b128 v[60:63], v45
    s_waitcnt lgkmcnt(3)
    v_mfma_f32_32x32x16_bf16 v[8:23], v[32:35], v[36:39], v[8:23]
    s_add_u32 s31, s31, 14336
    s_add_u32 m0, s30, 4096
    s_nop 0
    buffer_load_dwordx4 v4, s[20:23], s31 offen lds
    s_waitcnt vmcnt(3)
    ds_read_b64_tr_b16 v[24:25], v49 offset:1024
    ds_read_b64_tr_b16 v[26:27], v49 offset:1280
    ds_read_b128 v[28:31], v46
    s_waitcnt lgkmcnt(3)
    v_mfma_f32_32x32x16_bf16 v[8:23], v[56:59], v[60:63], v[8:23]
    s_add_u32 s31, s31, 14336
    s_add_u32 m0, s30, 0
    s_nop 0
    buffer_load_dwordx4 v4, s[20:23], s31 offen lds
    s_waitcnt vmcnt(3)
    ds_read_b64_tr_b16 v[32:33], v49 offset:2048
    ds_read_b64_tr_b16 v[34:35], v49 offset:2304
    ds_read_b128 v[36:39], v47
    s_waitcnt lgkmcnt(3)
    v_mfma_f32_32x32x16_bf16 v[8:23], v[24:27], v[28:31], v[8:23]
    s_add_u32 s31, s31, 14336
    s_add_u32 m0, s30, 1024
    s_nop 0
    buffer_load_dwordx4 v4, s[20:23], s31 offen lds
    s_add_u32 s14, s14, 1
    s_cmp_eq_u32 s14, 7
    s_cselect_b32 s10, -6, 1
    s_lshl_b32 s10, s10, 7
    v_add_u32 v44, s10, v44
    v_add_u32 v45, s10, v45
    v_add_u32 v46, s10, v46
    v_add_u32 v47, s10, v47
    s_waitcnt vmcnt(3)
    ds_read_b64_tr_b16 v[56:57], v49 offset:3072
    ds_read_b64_tr_b16 v[58:59], v49 offset:3328
    ds_read_b128 v[60:63], v44
    s_waitcnt lgkmcnt(3)
    v_mfma_f32_32x32x16_bf16 v[8:23], v[32:35], v[36:39], v[8:23]
    s_mul_i32 s31, s34, 57344
    s_add_u32 s31, s31, s13
    s_add_u32 s34, s34, 1
    s_cmp_eq_u32 s34, 7
    s_cselect_b32 s34, 0, s34
    s_add_u32 m0, s30, 2048
    s_nop 0
    buffer_load_dwordx4 v4, s[20:23], s31 offen lds
    s_waitcnt vmcnt(3)
    ds_read_b64_tr_b16 v[24:25], v49 offset:4096
    ds_read_b64_tr_b16 v[26:27], v49 offset:4352
    ds_read_b128 v[28:31], v45
    s_waitcnt lgkmcnt(3)
    v_mfma_f32_32x32x16_bf16 v[8:23], v[56:59], v[60:63], v[8:23]
    s_add_u32 s31, s31, 14336
    s_add_u32 m0, s30, 3072
    s_nop 0
    buffer_load_dwordx4 v4, s[20:23], s31 offen lds
    s_waitcnt vmcnt(3)
    ds_read_b64_tr_b16 v[32:33], v49 offset:0
    ds_read_b64_tr_b16 v[34:35], v49 offset:256
    ds_read_b128 v[36:39], v46
    s_waitcnt lgkmcnt(3)
    v_mfma_f32_32x32x16_bf16 v[8:23], v[24:27], v[28:31], v[8:23]
    s_add_u32 s31, s31, 14336
    s_add_u32 m0, s30, 4096
    s_nop 0
    buffer_load_dwordx4 v4, s[20:23], s31 offen lds
    s_waitcnt vmcnt(3)
    ds_read_b64_tr_b16 v[56:57], v49 offset:1024
    ds_read_b64_tr_b16 v[58:59], v49 offset:1280
    ds_read_b128 v[60:63], v47
    s_waitcnt lgkmcnt(3)
    v_mfma_f32_32x32x16_bf16 v[8:23], v[32:35], v[36:39], v[8:23]
    s_add_u32 s31, s31, 14336
    s_add_u32 m0, s30, 0
    s_nop 0
    buffer_load_dwordx4 v4, s[20:23], s31 offen lds
    s_add_u32 s14, s14, 1
    s_cmp_eq_u32 s14, 7
    s_cselect_b32 s10, -6, 1
    s_lshl_b32 s10, s10, 7
    v_add_u32 v44, s10, v44
    v_add_u32 v45, s10, v45
    v_add_u32 v46, s10, v46
    v_add_u32 v47, s10, v47
    s_waitcnt vmcnt(3)
    ds_read_b64_tr_b16 v[24:25], v49 offset:2048
    ds_read_b64_tr_b16 v[26:27], v49 offset:2304
    ds_read_b128 v[28:31], v44
    s_waitcnt lgkmcnt(3)
    v_mfma_f32_32x32x16_bf16 v[8:23], v[56:59], v[60:63], v[8:23]
    s_mul_i32 s31, s34, 57344
    s_add_u32 s31, s31, s13
    s_add_u32 s34, s34, 1
    s_cmp_eq_u32 s34, 7
    s_cselect_b32 s34, 0, s34
    s_add_u32 m0, s30, 1024
    s_nop 0
    buffer_load_dwordx4 v4, s[20:23], s31 offen lds
    s_waitcnt vmcnt(3)
    ds_read_b64_tr_b16 v[32:33], v49 offset:3072
    ds_read_b64_tr_b16 v[34:35], v49 offset:3328
    ds_read_b128 v[36:39], v45
    s_waitcnt lgkmcnt(3)
    v_mfma_f32_32x32x16_bf16 v[8:23], v[24:27], v[28:31], v[8:23]
    s_add_u32 s31, s31, 14336
    s_add_u32 m0, s30, 2048
    s_nop 0
    buffer_load_dwordx4 v4, s[20:23], s31 offen lds
    s_waitcnt vmcnt(3)
    ds_read_b64_tr_b16 v[56:57], v49 offset:4096
    ds_read_b64_tr_b16 v[58:59], v49 offset:4352
    ds_read_b128 v[60:63], v46
    s_waitcnt lgkmcnt(3)
    v_mfma_f32_32x32x16_bf16 v[8:23], v[32:35], v[36:39], v[8:23]
    s_add_u32 s31, s31, 14336
    s_add_u32 m0, s30, 3072
    s_nop 0
    buffer_load_dwordx4 v4, s[20:23], s31 offen lds
    s_waitcnt vmcnt(3)
    ds_read_b64_tr_b16 v[24:25], v49 offset:0
    ds_read_b64_tr_b16 v[26:27], v49 offset:256
    ds_read_b128 v[28:31], v47
    s_waitcnt lgkmcnt(3)
    v_mfma_f32_32x32x16_bf16 v[8:23], v[56:59], v[60:63], v[8:23]
    s_add_u32 s31, s31, 14336
    s_add_u32 m0, s30, 4096
    s_nop 0
    buffer_load_dwordx4 v4, s[20:23], s31 offen lds
    s_add_u32 s14, s14, 1
    s_cmp_eq_u32 s14, 7
    s_cselect_b32 s10, -6, 1
    s_lshl_b32 s10, s10, 7
    v_add_u32 v44, s10, v44
    v_add_u32 v45, s10, v45
    v_add_u32 v46, s10, v46
    v_add_u32 v47, s10, v47
    s_waitcnt vmcnt(3)
    ds_read_b64_tr_b16 v[32:33], v49 offset:1024
    ds_read_b64_tr_b16 v[34:35], v49 offset:1280
    ds_read_b128 v[36:39], v44
    s_waitcnt lgkmcnt(3)
    v_mfma_f32_32x32x16_bf16 v[8:23], v[24:27], v[28:31], v[8:23]
    s_mul_i32 s31, s34, 57344
    s_add_u32 s31, s31, s13
    s_add_u32 s34, s34, 1
    s_cmp_eq_u32 s34, 7
    s_cselect_b32 s34, 0, s34
    s_add_u32 m0, s30, 0
    s_nop 0
    buffer_load_dwordx4 v4, s[20:23], s31 offen lds
    s_waitcnt vmcnt(3)
    ds_read_b64_tr_b16 v[56:57], v49 offset:2048
    ds_read_b64_tr_b16 v[58:59], v49 offset:2304
    ds_read_b128 v[60:63], v45
    s_waitcnt lgkmcnt(3)
    v_mfma_f32_32x32x16_bf16 v[8:23], v[32:35], v[36:39], v[8:23]
    s_add_u32 s31, s31, 14336
    s_add_u32 m0, s30, 1024
    s_nop 0
    buffer_load_dwordx4 v4, s[20:23], s31 offen lds
    s_waitcnt vmcnt(3)
    ds_read_b64_tr_b16 v[24:25], v49 offset:3072
    ds_read_b64_tr_b16 v[26:27], v49 offset:3328
    ds_read_b128 v[28:31], v46
    s_waitcnt lgkmcnt(3)
    v_mfma_f32_32x32x16_bf16 v[8:23], v[56:59], v[60:63], v[8:23]
    s_add_u32 s31, s31, 14336
    s_add_u32 m0, s30, 2048
    s_nop 0
    buffer_load_dwordx4 v4, s[20:23], s31 offen lds
    s_waitcnt vmcnt(3)
    ds_read_b64_tr_b16 v[32:33], v49 offset:4096
    ds_read_b64_tr_b16 v[34:35], v49 offset:4352
    ds_read_b128 v[36:39], v47
    s_waitcnt lgkmcnt(3)
    v_mfma_f32_32x32x16_bf16 v[8:23], v[24:27], v[28:31], v[8:23]
    s_add_u32 s31, s31, 14336
    s_add_u32 m0, s30, 3072
    s_nop 0
    buffer_load_dwordx4 v4, s[20:23], s31 offen lds
    s_add_u32 s14, s14, 1
    s_cmp_eq_u32 s14, 7
    s_cselect_b32 s10, -6, 1
    s_lshl_b32 s10, s10, 7
    v_add_u32 v44, s10, v44
    v_add_u32 v45, s10, v45
    v_add_u32 v46, s10, v46
    v_add_u32 v47, s10, v47
    s_waitcnt vmcnt(3)
    ds_read_b64_tr_b16 v[56:57], v49 offset:0
    ds_read_b64_tr_b16 v[58:59], v49 offset:256
    ds_read_b128 v[60:63], v44
    s_waitcnt lgkmcnt(3)
    v_mfma_f32_32x32x16_bf16 v[8:23], v[32:35], v[36:39], v[8:23]
    s_mul_i32 s31, s34, 57344
    s_add_u32 s31, s31, s13
    s_add_u32 s34, s34, 1
    s_cmp_eq_u32 s34, 7
    s_cselect_b32 s34, 0, s34
    s_add_u32 m0, s30, 4096
    s_nop 0
    buffer_load_dwordx4 v4, s[20:23], s31 offen lds
    s_waitcnt vmcnt(3)
    ds_read_b64_tr_b16 v[24:25], v49 offset:1024
    ds_read_b64_tr_b16 v[26:27], v49 offset:1280
    ds_read_b128 v[28:31], v45
    s_waitcnt lgkmcnt(3)
    v_mfma_f32_32x32x16_bf16 v[8:23], v[56:59], v[60:63], v[8:23]
    s_add_u32 s31, s31, 14336
    s_add_u32 m0, s30, 0
    s_nop 0
    buffer_load_dwordx4 v4, s[20:23], s31 offen lds
    s_waitcnt vmcnt(3)
    ds_read_b64_tr_b16 v[32:33], v49 offset:2048
    ds_read_b64_tr_b16 v[34:35], v49 offset:2304
    ds_read_b128 v[36:39], v46
    s_waitcnt lgkmcnt(3)
    v_mfma_f32_32x32x16_bf16 v[8:23], v[24:27], v[28:31], v[8:23]
    s_add_u32 s31, s31, 14336
    s_add_u32 m0, s30, 1024
    s_nop 0
    buffer_load_dwordx4 v4, s[20:23], s31 offen lds
    s_waitcnt vmcnt(3)
    ds_read_b64_tr_b16 v[56:57], v49 offset:3072
    ds_read_b64_tr_b16 v[58:59], v49 offset:3328
    ds_read_b128 v[60:63], v47
    s_waitcnt lgkmcnt(3)
    v_mfma_f32_32x32x16_bf16 v[8:23], v[32:35], v[36:39], v[8:23]
    s_add_u32 s31, s31, 14336
    s_add_u32 m0, s30, 2048
    s_nop 0
    buffer_load_dwordx4 v4, s[20:23], s31 offen lds
    s_add_u32 s14, s14, 1
    s_cmp_eq_u32 s14, 7
    s_cselect_b32 s10, -6, 1
    s_lshl_b32 s10, s10, 7
    v_add_u32 v44, s10, v44
    v_add_u32 v45, s10, v45
    v_add_u32 v46, s10, v46
    v_add_u32 v47, s10, v47
    s_waitcnt vmcnt(3)
    ds_read_b64_tr_b16 v[24:25], v49 offset:4096
    ds_read_b64_tr_b16 v[26:27], v49 offset:4352
    ds_read_b128 v[28:31], v44
    s_waitcnt lgkmcnt(3)
    v_mfma_f32_32x32x16_bf16 v[8:23], v[56:59], v[60:63], v[8:23]
    s_waitcnt vmcnt(2)
    ds_read_b64_tr_b16 v[32:33], v49 offset:0
    ds_read_b64_tr_b16 v[34:35], v49 offset:256
    ds_read_b128 v[36:39], v45
    s_waitcnt lgkmcnt(3)
    v_mfma_f32_32x32x16_bf16 v[8:23], v[24:27], v[28:31], v[8:23]
    s_waitcnt vmcnt(1)
    ds_read_b64_tr_b16 v[56:57], v49 offset:1024
    ds_read_b64_tr_b16 v[58:59], v49 offset:1280
    ds_read_b128 v[60:63], v46
    s_waitcnt lgkmcnt(3)
    v_mfma_f32_32x32x16_bf16 v[8:23], v[32:35], v[36:39], v[8:23]
    s_waitcnt vmcnt(0)
    ds_read_b64_tr_b16 v[24:25], v49 offset:2048
    ds_read_b64_tr_b16 v[26:27], v49 offset:2304
    ds_read_b128 v[28:31], v47
    s_waitcnt lgkmcnt(3)
    v_mfma_f32_32x32x16_bf16 v[8:23], v[56:59], v[60:63], v[8:23]
    s_waitcnt lgkmcnt(0)
    v_mfma_f32_32x32x16_bf16 v[8:23], v[24:27], v[28:31], v[8:23]
    s_mov_b32 s10, 0x3e8b97f6
    s_nop 10
    v_mul_f32 v8, s10, v8
    v_mul_f32 v9, s10, v9
    v_mul_f32 v10, s10, v10
    v_mul_f32 v11, s10, v11
    v_mul_f32 v12, s10, v12
    v_mul_f32 v13, s10, v13
    v_mul_f32 v14, s10, v14
    v_mul_f32 v15, s10, v15
    v_mul_f32 v16, s10, v16
    v_mul_f32 v17, s10, v17
    v_mul_f32 v18, s10, v18
    v_mul_f32 v19, s10, v19
    v_mul_f32 v20, s10, v20
    v_mul_f32 v21, s10, v21
    v_mul_f32 v22, s10, v22
    v_mul_f32 v23, s10, v23
    v_cvt_pk_bf16_f32 v24, v8, v9
    v_cvt_pk_bf16_f32 v25, v10, v11
    v_cvt_pk_bf16_f32 v26, v12, v13
    v_cvt_pk_bf16_f32 v27, v14, v15
    v_cvt_pk_bf16_f32 v28, v16, v17
    v_cvt_pk_bf16_f32 v29, v18, v19
    v_cvt_pk_bf16_f32 v30, v20, v21
    v_cvt_pk_bf16_f32 v31, v22, v23
    s_mov_b32 exec_lo, 0x0
    s_mov_b32 exec_hi, 0xffffffff
    v_mov_b32 v30, 0
    v_mov_b32 v31, 0
    s_mov_b64 exec, -1
    ds_write_b128 v48, v[24:27]
    ds_write_b128 v48, v[28:31] offset:1024
    s_mov_b32 s30, 401408
    s_mov_b32 s31, 0x20000
    v_lshlrev_b32 v5, 6, v2
    v_and_b32 v5, 0x7ff, v5
    s_lshl_b32 s10, s4, 13
    s_lshl_b32 s20, s7, 11
    s_add_u32 s20, s20, 98304
    s_lshl_b32 s35, s9, 6
    s_add_u32 s35, s35, s20
    s_lshl_b32 s14, s45, 2
    s_add_u32 s15, s14, s4
    s_min_u32 s22, s15, 13
    s_lshl_b32 s16, s22, 6
    s_mov_b32 s17, s45
    s_add_u32 s18, s10, 98304
    v_lshrrev_b32 v6, 2, v2
    v_mul_u32_u24 v6, 896, v6
    v_and_b32 v7, 3, v2
    v_lshl_add_u32 v6, v7, 4, v6
    v_lshrrev_b32 v20, 5, v2
    v_bfe_u32 v21, v2, 2, 2
    v_lshlrev_b32 v7, 3, v7
    v_and_b32 v22, 16, v2
    v_lshl_add_u32 v7, v22, 1, v7
    v_add_u32 v7, s18, v7
    v_lshl_add_u32 v22, v20, 2, v21
    v_lshl_add_u32 v22, v22, 6, v7
    v_mul_u32_u24 v23, 3, v20
    v_add3_u32 v23, v23, v21, 8
    v_lshl_add_u32 v23, v23, 6, v7
    v_lshrrev_b32 v4, 1, v2
    v_lshlrev_b32 v4, 12, v4
    v_and_b32 v8, 1, v2
    v_lshl_add_u32 v4, v8, 4, v4
    s_lshl_b32 s12, s7, 18
    s_lshl_b32 s13, s9, 7
    s_add_u32 s12, s12, s13
    s_lshl_b32 s13, s4, 5
    s_add_u32 s12, s12, s13
    s_lshl_b32 s13, s4, 11
    s_add_u32 s13, s13, 131072
    v_lshrrev_b32 v8, 4, v2
    v_lshl_add_u32 v9, v8, 3, v21
    v_lshlrev_b32 v9, 5, v9
    v_and_b32 v10, 3, v2
    v_lshl_add_u32 v9, v10, 3, v9
    v_add_u32 v9, s13, v9
    v_and_b32 v10, 15, v2
    v_mul_u32_u24 v10, 1792, v10
    v_lshl_add_u32 v10, v8, 4, v10
    s_lshl_b32 s19, s9, 2
    s_add_u32 s19, s19, s4
    s_mul_i32 s19, s19, 28672
    s_lshl_b32 s21, s7, 7
    s_add_u32 s19, s19, s21
    v_and_b32 v11, 31, v2
    v_mul_u32_u24 v11, 1792, v11
    v_lshl_add_u32 v11, v20, 4, v11
    v_add_u32 v8, 32768, v3
    s_mul_i32 s22, s44, 57344
    s_lshl_b32 s23, s15, 6
    s_add_u32 s22, s22, s23
    s_add_u32 s22, s22, 896
    s_waitcnt lgkmcnt(0)
    s_barrier
    s_setprio 3
    s_add_u32 m0, s10, 65536
    s_add_u32 s11, s10, 65536
    buffer_load_dwordx4 v3, s[52:55], s11 offen offset:0 sc1 lds
    buffer_load_dwordx4 v3, s[52:55], s11 offen offset:1024 sc1 lds
    buffer_load_dwordx4 v3, s[52:55], s11 offen offset:2048 sc1 lds
    buffer_load_dwordx4 v3, s[52:55], s11 offen offset:3072 sc1 lds
    s_add_u32 m0, s10, 69632
    s_add_u32 s11, s10, 69632
    buffer_load_dwordx4 v3, s[52:55], s11 offen offset:0 sc1 lds
    buffer_load_dwordx4 v3, s[52:55], s11 offen offset:1024 sc1 lds
    buffer_load_dwordx4 v3, s[52:55], s11 offen offset:2048 sc1 lds
    buffer_load_dwordx4 v3, s[52:55], s11 offen offset:3072 sc1 lds
    s_mul_i32 s11, s17, 100352
    s_add_u32 s11, s11, s16
    s_add_u32 s17, s17, 1
    s_and_b32 s17, s17, 3
    s_add_u32 m0, s18, 0
    s_nop 0
    buffer_load_dwordx4 v6, s[28:31], s11 offen lds
    s_add_u32 s11, s11, 14336
    s_add_u32 m0, s18, 1024
    s_nop 0
    buffer_load_dwordx4 v6, s[28:31], s11 offen lds
    s_add_u32 s11, s11, 14336
    s_add_u32 m0, s18, 2048
    s_nop 0
    buffer_load_dwordx4 v6, s[28:31], s11 offen lds
    s_add_u32 s11, s11, 14336
    s_add_u32 m0, s18, 3072
    s_nop 0
    buffer_load_dwordx4 v6, s[28:31], s11 offen lds
    s_add_u32 s11, s11, 14336
    s_add_u32 m0, s18, 4096
    s_nop 0
    buffer_load_dwordx4 v6, s[28:31], s11 offen lds
    s_add_u32 s11, s11, 14336
    s_add_u32 m0, s18, 5120
    s_nop 0
    buffer_load_dwordx4 v6, s[28:31], s11 offen lds
    s_add_u32 s11, s11, 14336
    s_add_u32 m0, s18, 6144
    s_nop 0
    buffer_load_dwordx4 v6, s[28:31], s11 offen lds
    s_add_u32 s11, s11, 14336
    s_add_u32 m0, s18, 7168
    s_nop 0
    buffer_load_dwordx4 v6, s[28:31], s11 offen lds
    s_barrier
    s_cmp_eq_u32 s7, 7
    s_cbranch_scc1 C_noyf
    s_cmp_lg_u32 s4, 0
    s_cbranch_scc1 C_noyf
    s_mov_b64 exec, 1
    buffer_store_dword v1, v0, s[48:51], s35 offen sc1
    s_mov_b64 exec, -1
C_noyf:
    s_waitcnt vmcnt(0)
    ds_read_b64_tr_b16 v[40:41], v22 offset:0
    ds_read_b64_tr_b16 v[42:43], v23 offset:0
    ds_read_b64_tr_b16 v[44:45], v22 offset:896
    ds_read_b64_tr_b16 v[46:47], v23 offset:896
    ds_read_b64_tr_b16 v[48:49], v22 offset:1792
    ds_read_b64_tr_b16 v[50:51], v23 offset:1792
    ds_read_b64_tr_b16 v[52:53], v22 offset:2688
    ds_read_b64_tr_b16 v[54:55], v23 offset:2688
    ds_read_b64_tr_b16 v[56:57], v22 offset:3584
    ds_read_b64_tr_b16 v[58:59], v23 offset:3584
    ds_read_b64_tr_b16 v[60:61], v22 offset:4480
    ds_read_b64_tr_b16 v[62:63], v23 offset:4480
    ds_read_b64_tr_b16 v[64:65], v22 offset:5376
    ds_read_b64_tr_b16 v[66:67], v23 offset:5376
    ds_read_b64_tr_b16 v[68:69], v22 offset:6272
    ds_read_b64_tr_b16 v[70:71], v23 offset:6272
    s_waitcnt lgkmcnt(0)
    s_mul_i32 s11, s17, 100352
    s_add_u32 s11, s11, s16
    s_add_u32 s17, s17, 1
    s_and_b32 s17, s17, 3
    s_add_u32 m0, s18, 0
    s_nop 0
    buffer_load_dwordx4 v6, s[28:31], s11 offen lds
    s_add_u32 s11, s11, 14336
    s_add_u32 m0, s18, 1024
    s_nop 0
    buffer_load_dwordx4 v6, s[28:31], s11 offen lds
    s_add_u32 s11, s11, 14336
    s_add_u32 m0, s18, 2048
    s_nop 0
    buffer_load_dwordx4 v6, s[28:31], s11 offen lds
    s_add_u32 s11, s11, 14336
    s_add_u32 m0, s18, 3072
    s_nop 0
    buffer_load_dwordx4 v6, s[28:31], s11 offen lds
    s_add_u32 s11, s11, 14336
    s_add_u32 m0, s18, 4096
    s_nop 0
    buffer_load_dwordx4 v6, s[28:31], s11 offen lds
    s_add_u32 s11, s11, 14336
    s_add_u32 m0, s18, 5120
    s_nop 0
    buffer_load_dwordx4 v6, s[28:31], s11 offen lds
    s_add_u32 s11, s11, 14336
    s_add_u32 m0, s18, 6144
    s_nop 0
    buffer_load_dwordx4 v6, s[28:31], s11 offen lds
    s_add_u32 s11, s11, 14336
    s_add_u32 m0, s18, 7168
    s_nop 0
    buffer_load_dwordx4 v6, s[28:31], s11 offen lds
    s_barrier
    s_add_u32 m0, s10, 0
    s_add_u32 s11, s10, 98304
    buffer_load_dwordx4 v3, s[52:55], s11 offen offset:0 sc1 lds
    buffer_load_dwordx4 v3, s[52:55], s11 offen offset:1024 sc1 lds
    buffer_load_dwordx4 v3, s[52:55], s11 offen offset:2048 sc1 lds
    buffer_load_dwordx4 v3, s[52:55], s11 offen offset:3072 sc1 lds
    s_add_u32 m0, s10, 4096
    s_add_u32 s11, s10, 102400
    buffer_load_dwordx4 v3, s[52:55], s11 offen offset:0 sc1 lds
    buffer_load_dwordx4 v3, s[52:55], s11 offen offset:1024 sc1 lds
    buffer_load_dwordx4 v3, s[52:55], s11 offen offset:2048 sc1 lds
    buffer_load_dwordx4 v3, s[52:55], s11 offen offset:3072 sc1 lds
    s_waitcnt vmcnt(8)
    ds_read_b64_tr_b16 v[72:73], v22 offset:0
    ds_read_b64_tr_b16 v[74:75], v23 offset:0
    ds_read_b64_tr_b16 v[76:77], v22 offset:896
    ds_read_b64_tr_b16 v[78:79], v23 offset:896
    ds_read_b64_tr_b16 v[80:81], v22 offset:1792
    ds_read_b64_tr_b16 v[82:83], v23 offset:1792
    ds_read_b64_tr_b16 v[84:85], v22 offset:2688
    ds_read_b64_tr_b16 v[86:87], v23 offset:2688
    ds_read_b64_tr_b16 v[88:89], v22 offset:3584
    ds_read_b64_tr_b16 v[90:91], v23 offset:3584
    ds_read_b64_tr_b16 v[92:93], v22 offset:4480
    ds_read_b64_tr_b16 v[94:95], v23 offset:4480
    ds_read_b64_tr_b16 v[96:97], v22 offset:5376
    ds_read_b64_tr_b16 v[98:99], v23 offset:5376
    ds_read_b64_tr_b16 v[100:101], v22 offset:6272
    ds_read_b64_tr_b16 v[102:103], v23 offset:6272
    s_waitcnt lgkmcnt(0)
    s_mul_i32 s11, s17, 100352
    s_add_u32 s11, s11, s16
    s_add_u32 s17, s17, 1
    s_and_b32 s17, s17, 3
    s_add_u32 m0, s18, 0
    s_nop 0
    buffer_load_dwordx4 v6, s[28:31], s11 offen lds
    s_add_u32 s11, s11, 14336
    s_add_u32 m0, s18, 1024
    s_nop 0
    buffer_load_dwordx4 v6, s[28:31], s11 offen lds
    s_add_u32 s11, s11, 14336
    s_add_u32 m0, s18, 2048
    s_nop 0
    buffer_load_dwordx4 v6, s[28:31], s11 offen lds
    s_add_u32 s11, s11, 14336
    s_add_u32 m0, s18, 3072
    s_nop 0
    buffer_load_dwordx4 v6, s[28:31], s11 offen lds
    s_add_u32 s11, s11, 14336
    s_add_u32 m0, s18, 4096
    s_nop 0
    buffer_load_dwordx4 v6, s[28:31], s11 offen lds
    s_add_u32 s11, s11, 14336
    s_add_u32 m0, s18, 5120
    s_nop 0
    buffer_load_dwordx4 v6, s[28:31], s11 offen lds
    s_add_u32 s11, s11, 14336
    s_add_u32 m0, s18, 6144
    s_nop 0
    buffer_load_dwordx4 v6, s[28:31], s11 offen lds
    s_add_u32 s11, s11, 14336
    s_add_u32 m0, s18, 7168
    s_nop 0
    buffer_load_dwordx4 v6, s[28:31], s11 offen lds
    s_waitcnt vmcnt(8)
    s_barrier
    s_add_u32 m0, s10, 32768
    s_add_u32 s11, s10, 131072
    buffer_load_dwordx4 v3, s[52:55], s11 offen offset:0 sc1 lds
    buffer_load_dwordx4 v3, s[52:55], s11 offen offset:1024 sc1 lds
    buffer_load_dwordx4 v3, s[52:55], s11 offen offset:2048 sc1 lds
    buffer_load_dwordx4 v3, s[52:55], s11 offen offset:3072 sc1 lds
    s_add_u32 m0, s10, 36864
    s_add_u32 s11, s10, 135168
    buffer_load_dwordx4 v3, s[52:55], s11 offen offset:0 sc1 lds
    buffer_load_dwordx4 v3, s[52:55], s11 offen offset:1024 sc1 lds
    buffer_load_dwordx4 v3, s[52:55], s11 offen offset:2048 sc1 lds
    buffer_load_dwordx4 v3, s[52:55], s11 offen offset:3072 sc1 lds
    s_waitcnt vmcnt(8)
    ds_read_b64_tr_b16 v[104:105], v22 offset:0
    ds_read_b64_tr_b16 v[106:107], v23 offset:0
    ds_read_b64_tr_b16 v[108:109], v22 offset:896
    ds_read_b64_tr_b16 v[110:111], v23 offset:896
    ds_read_b64_tr_b16 v[112:113], v22 offset:1792
    ds_read_b64_tr_b16 v[114:115], v23 offset:1792
    ds_read_b64_tr_b16 v[116:117], v22 offset:2688
    ds_read_b64_tr_b16 v[118:119], v23 offset:2688
    ds_read_b64_tr_b16 v[120:121], v22 offset:3584
    ds_read_b64_tr_b16 v[122:123], v23 offset:3584
    ds_read_b64_tr_b16 v[124:125], v22 offset:4480
    ds_read_b64_tr_b16 v[126:127], v23 offset:4480
    ds_read_b64_tr_b16 v[128:129], v22 offset:5376
    ds_read_b64_tr_b16 v[130:131], v23 offset:5376
    ds_read_b64_tr_b16 v[132:133], v22 offset:6272
    ds_read_b64_tr_b16 v[134:135], v23 offset:6272
    s_waitcnt lgkmcnt(0)
    s_mul_i32 s11, s17, 100352
    s_add_u32 s11, s11, s16
    s_add_u32 s17, s17, 1
    s_and_b32 s17, s17, 3
    s_add_u32 m0, s18, 0
    s_nop 0
    buffer_load_dwordx4 v6, s[28:31], s11 offen lds
    s_add_u32 s11, s11, 14336
    s_add_u32 m0, s18, 1024
    s_nop 0
    buffer_load_dwordx4 v6, s[28:31], s11 offen lds
    s_add_u32 s11, s11, 14336
    s_add_u32 m0, s18, 2048
    s_nop 0
    buffer_load_dwordx4 v6, s[28:31], s11 offen lds
    s_add_u32 s11, s11, 14336
    s_add_u32 m0, s18, 3072
    s_nop 0
    buffer_load_dwordx4 v6, s[28:31], s11 offen lds
    s_add_u32 s11, s11, 14336
    s_add_u32 m0, s18, 4096
    s_nop 0
    buffer_load_dwordx4 v6, s[28:31], s11 offen lds
    s_add_u32 s11, s11, 14336
    s_add_u32 m0, s18, 5120
    s_nop 0
    buffer_load_dwordx4 v6, s[28:31], s11 offen lds
    s_add_u32 s11, s11, 14336
    s_add_u32 m0, s18, 6144
    s_nop 0
    buffer_load_dwordx4 v6, s[28:31], s11 offen lds
    s_add_u32 s11, s11, 14336
    s_add_u32 m0, s18, 7168
    s_nop 0
    buffer_load_dwordx4 v6, s[28:31], s11 offen lds
    s_waitcnt vmcnt(8)
    s_barrier
    s_add_u32 m0, s10, 65536
    s_add_u32 s11, s10, 163840
    buffer_load_dwordx4 v3, s[52:55], s11 offen offset:0 sc1 lds
    buffer_load_dwordx4 v3, s[52:55], s11 offen offset:1024 sc1 lds
    buffer_load_dwordx4 v3, s[52:55], s11 offen offset:2048 sc1 lds
    buffer_load_dwordx4 v3, s[52:55], s11 offen offset:3072 sc1 lds
    s_add_u32 m0, s10, 69632
    s_add_u32 s11, s10, 167936
    buffer_load_dwordx4 v3, s[52:55], s11 offen offset:0 sc1 lds
    buffer_load_dwordx4 v3, s[52:55], s11 offen offset:1024 sc1 lds
    buffer_load_dwordx4 v3, s[52:55], s11 offen offset:2048 sc1 lds
    buffer_load_dwordx4 v3, s[52:55], s11 offen offset:3072 sc1 lds
    s_waitcnt vmcnt(8)
    ds_read_b64_tr_b16 v[136:137], v22 offset:0
    ds_read_b64_tr_b16 v[138:139], v23 offset:0
    ds_read_b64_tr_b16 v[140:141], v22 offset:896
    ds_read_b64_tr_b16 v[142:143], v23 offset:896
    ds_read_b64_tr_b16 v[144:145], v22 offset:1792
    ds_read_b64_tr_b16 v[146:147], v23 offset:1792
    ds_read_b64_tr_b16 v[148:149], v22 offset:2688
    ds_read_b64_tr_b16 v[150:151], v23 offset:2688
    ds_read_b64_tr_b16 v[152:153], v22 offset:3584
    ds_read_b64_tr_b16 v[154:155], v23 offset:3584
    ds_read_b64_tr_b16 v[156:157], v22 offset:4480
    ds_read_b64_tr_b16 v[158:159], v23 offset:4480
    ds_read_b64_tr_b16 v[160:161], v22 offset:5376
    ds_read_b64_tr_b16 v[162:163], v23 offset:5376
    ds_read_b64_tr_b16 v[164:165], v22 offset:6272
    ds_read_b64_tr_b16 v[166:167], v23 offset:6272
    s_waitcnt lgkmcnt(0)
    s_add_u32 s24, s42, 0x280000
    s_addc_u32 s25, s43, 0
    s_mov_b32 s26, 0x200000
    s_mov_b32 s27, 0x20000
    s_lshl_b32 s23, s44, 4
    s_add_u32 s23, s23, s15
    s_lshl_b32 s23, s23, 11
    buffer_load_dwordx4 v[12:15], v3, s[24:27], s23 offen sc1
    buffer_load_dwordx4 v[16:19], v3, s[24:27], s23 offen offset:1024 sc1
    s_waitcnt vmcnt(0)
    s_barrier
    s_add_u32 m0, s10, 0
    s_add_u32 s11, s10, 196608
    buffer_load_dwordx4 v3, s[52:55], s11 offen offset:0 sc1 lds
    buffer_load_dwordx4 v3, s[52:55], s11 offen offset:1024 sc1 lds
    buffer_load_dwordx4 v3, s[52:55], s11 offen offset:2048 sc1 lds
    buffer_load_dwordx4 v3, s[52:55], s11 offen offset:3072 sc1 lds
    s_add_u32 m0, s10, 4096
    s_add_u32 s11, s10, 200704
    buffer_load_dwordx4 v3, s[52:55], s11 offen offset:0 sc1 lds
    buffer_load_dwordx4 v3, s[52:55], s11 offen offset:1024 sc1 lds
    buffer_load_dwordx4 v3, s[52:55], s11 offen offset:2048 sc1 lds
    buffer_load_dwordx4 v3, s[52:55], s11 offen offset:3072 sc1 lds
    s_cmp_eq_u32 s7, 7
    s_cbranch_scc1 C_noy
    s_mov_b32 s47, 0
CY_poll:
    buffer_load_dword v12, v5, s[48:51], s20 offen sc1
    s_add_u32 s47, s47, 1
    s_waitcnt vmcnt(0)
    v_cmp_ne_u32 vcc, s46, v12
    s_cbranch_vccz CY_ok
    s_cmp_lt_u32 s47, 400000
    s_sleep 4
    s_cbranch_scc1 CY_poll
CY_ok:
    s_mov_b32 m0, s13
    s_add_u32 s11, s12, 0x20000
    buffer_load_dwordx4 v4, s[60:63], s12 offen sc1 lds
    s_add_u32 m0, s13, 1024
    s_nop 0
    buffer_load_dwordx4 v4, s[60:63], s11 offen sc1 lds
    s_barrier
    s_add_u32 m0, s10, 32768
    s_add_u32 s11, s10, 229376
    buffer_load_dwordx4 v3, s[52:55], s11 offen offset:0 sc1 lds
    buffer_load_dwordx4 v3, s[52:55], s11 offen offset:1024 sc1 lds
    buffer_load_dwordx4 v3, s[52:55], s11 offen offset:2048 sc1 lds
    buffer_load_dwordx4 v3, s[52:55], s11 offen offset:3072 sc1 lds
    s_add_u32 m0, s10, 36864
    s_add_u32 s11, s10, 233472
    buffer_load_dwordx4 v3, s[52:55], s11 offen offset:0 sc1 lds
    buffer_load_dwordx4 v3, s[52:55], s11 offen offset:1024 sc1 lds
    buffer_load_dwordx4 v3, s[52:55], s11 offen offset:2048 sc1 lds
    buffer_load_dwordx4 v3, s[52:55], s11 offen offset:3072 sc1 lds
    s_waitcnt vmcnt(8)
    ds_read_b64_tr_b16 v[12:13], v9 offset:0
    ds_read_b64_tr_b16 v[14:15], v9 offset:128
    ds_read_b64_tr_b16 v[16:17], v9 offset:1024
    ds_read_b64_tr_b16 v[18:19], v9 offset:1152
    s_waitcnt lgkmcnt(0)
    buffer_store_dwordx4 v[12:15], v10, s[36:39], s19 offen sc1
    buffer_store_dwordx4 v[16:19], v10, s[36:39], s19 offen offset:64 sc1
    s_waitcnt vmcnt(2)
    s_branch C_y2
C_noy:
    s_waitcnt vmcnt(0)
    s_barrier
    s_add_u32 m0, s10, 32768
    s_add_u32 s11, s10, 229376
    buffer_load_dwordx4 v3, s[52:55], s11 offen offset:0 sc1 lds
    buffer_load_dwordx4 v3, s[52:55], s11 offen offset:1024 sc1 lds
    buffer_load_dwordx4 v3, s[52:55], s11 offen offset:2048 sc1 lds
    buffer_load_dwordx4 v3, s[52:55], s11 offen offset:3072 sc1 lds
    s_add_u32 m0, s10, 36864
    s_add_u32 s11, s10, 233472
    buffer_load_dwordx4 v3, s[52:55], s11 offen offset:0 sc1 lds
    buffer_load_dwordx4 v3, s[52:55], s11 offen offset:1024 sc1 lds
    buffer_load_dwordx4 v3, s[52:55], s11 offen offset:2048 sc1 lds
    buffer_load_dwordx4 v3, s[52:55], s11 offen offset:3072 sc1 lds
    s_waitcnt vmcnt(0)
C_y2:
    s_barrier
    s_barrier
    s_waitcnt vmcnt(0)
    s_barrier
    s_barrier
    ds_read_b128 v[12:15], v8 offset:0
    ds_read_b128 v[16:19], v8 offset:1024
    ds_read_b128 v[20:23], v8 offset:2048
    ds_read_b128 v[4:7], v8 offset:3072
    s_waitcnt lgkmcnt(3)
    v_mfma_f32_32x32x16_bf16 v[24:39], v[40:43], v[12:15], 0
    ds_read_b128 v[12:15], v8 offset:4096
    s_waitcnt lgkmcnt(3)
    v_mfma_f32_32x32x16_bf16 v[24:39], v[44:47], v[16:19], v[24:39]
    ds_read_b128 v[16:19], v8 offset:5120
    s_waitcnt lgkmcnt(3)
    v_mfma_f32_32x32x16_bf16 v[24:39], v[48:51], v[20:23], v[24:39]
    ds_read_b128 v[20:23], v8 offset:6144
    s_waitcnt lgkmcnt(3)
    v_mfma_f32_32x32x16_bf16 v[24:39], v[52:55], v[4:7], v[24:39]
    ds_read_b128 v[4:7], v8 offset:7168
    s_waitcnt lgkmcnt(3)
    v_mfma_f32_32x32x16_bf16 v[24:39], v[56:59], v[12:15], v[24:39]
    s_waitcnt lgkmcnt(2)
    v_mfma_f32_32x32x16_bf16 v[24:39], v[60:63], v[16:19], v[24:39]
    s_waitcnt lgkmcnt(1)
    v_mfma_f32_32x32x16_bf16 v[24:39], v[64:67], v[20:23], v[24:39]
    s_waitcnt lgkmcnt(0)
    v_mfma_f32_32x32x16_bf16 v[24:39], v[68:71], v[4:7], v[24:39]
    s_barrier
    ds_read_b128 v[12:15], v8 offset:8192
    ds_read_b128 v[16:19], v8 offset:9216
    ds_read_b128 v[20:23], v8 offset:10240
    ds_read_b128 v[4:7], v8 offset:11264
    s_waitcnt lgkmcnt(3)
    v_mfma_f32_32x32x16_bf16 v[24:39], v[72:75], v[12:15], v[24:39]
    ds_read_b128 v[12:15], v8 offset:12288
    s_waitcnt lgkmcnt(3)
    v_mfma_f32_32x32x16_bf16 v[24:39], v[76:79], v[16:19], v[24:39]
    ds_read_b128 v[16:19], v8 offset:13312
    s_waitcnt lgkmcnt(3)
    v_mfma_f32_32x32x16_bf16 v[24:39], v[80:83], v[20:23], v[24:39]
    ds_read_b128 v[20:23], v8 offset:14336
    s_waitcnt lgkmcnt(3)
    v_mfma_f32_32x32x16_bf16 v[24:39], v[84:87], v[4:7], v[24:39]
    ds_read_b128 v[4:7], v8 offset:15360
    s_waitcnt lgkmcnt(3)
    v_mfma_f32_32x32x16_bf16 v[24:39], v[88:91], v[12:15], v[24:39]
    ds_read_b128 v[12:15], v8 offset:16384
    s_waitcnt lgkmcnt(3)
    v_mfma_f32_32x32x16_bf16 v[24:39], v[92:95], v[16:19], v[24:39]
    ds_read_b128 v[16:19], v8 offset:17408
    s_waitcnt lgkmcnt(3)
    v_mfma_f32_32x32x16_bf16 v[24:39], v[96:99], v[20:23], v[24:39]
    ds_read_b128 v[20:23], v8 offset:18432
    s_waitcnt lgkmcnt(3)
    v_mfma_f32_32x32x16_bf16 v[24:39], v[100:103], v[4:7], v[24:39]
    ds_read_b128 v[4:7], v8 offset:19456
    s_waitcnt lgkmcnt(3)
    v_mfma_f32_32x32x16_bf16 v[24:39], v[104:107], v[12:15], v[24:39]
    ds_read_b128 v[12:15], v8 offset:20480
    s_waitcnt lgkmcnt(3)
    v_mfma_f32_32x32x16_bf16 v[24:39], v[108:111], v[16:19], v[24:39]
    ds_read_b128 v[16:19], v8 offset:21504
    s_waitcnt lgkmcnt(3)
    v_mfma_f32_32x32x16_bf16 v[24:39], v[112:115], v[20:23], v[24:39]
    ds_read_b128 v[20:23], v8 offset:22528
    s_waitcnt lgkmcnt(3)
    v_mfma_f32_32x32x16_bf16 v[24:39], v[116:119], v[4:7], v[24:39]
    ds_read_b128 v[4:7], v8 offset:23552
    s_waitcnt lgkmcnt(3)
    v_mfma_f32_32x32x16_bf16 v[24:39], v[120:123], v[12:15], v[24:39]
    ds_read_b128 v[12:15], v8 offset:24576
    s_waitcnt lgkmcnt(3)
    v_mfma_f32_32x32x16_bf16 v[24:39], v[124:127], v[16:19], v[24:39]
    ds_read_b128 v[16:19], v8 offset:25600
    s_waitcnt lgkmcnt(3)
    v_mfma_f32_32x32x16_bf16 v[24:39], v[128:131], v[20:23], v[24:39]
    ds_read_b128 v[20:23], v8 offset:26624
    s_waitcnt lgkmcnt(3)
    v_mfma_f32_32x32x16_bf16 v[24:39], v[132:135], v[4:7], v[24:39]
    ds_read_b128 v[4:7], v8 offset:27648
    s_waitcnt lgkmcnt(3)
    v_mfma_f32_32x32x16_bf16 v[24:39], v[136:139], v[12:15], v[24:39]
    ds_read_b128 v[12:15], v8 offset:28672
    s_waitcnt lgkmcnt(3)
    v_mfma_f32_32x32x16_bf16 v[24:39], v[140:143], v[16:19], v[24:39]
    ds_read_b128 v[16:19], v8 offset:29696
    s_waitcnt lgkmcnt(3)
    v_mfma_f32_32x32x16_bf16 v[24:39], v[144:147], v[20:23], v[24:39]
    ds_read_b128 v[20:23], v8 offset:30720
    s_waitcnt lgkmcnt(3)
    v_mfma_f32_32x32x16_bf16 v[24:39], v[148:151], v[4:7], v[24:39]
    ds_read_b128 v[4:7], v8 offset:31744
    s_waitcnt lgkmcnt(3)
    v_mfma_f32_32x32x16_bf16 v[24:39], v[152:155], v[12:15], v[24:39]
    s_waitcnt lgkmcnt(2)
    v_mfma_f32_32x32x16_bf16 v[24:39], v[156:159], v[16:19], v[24:39]
    s_waitcnt lgkmcnt(1)
    v_mfma_f32_32x32x16_bf16 v[24:39], v[160:163], v[20:23], v[24:39]
    s_waitcnt lgkmcnt(0)
    v_mfma_f32_32x32x16_bf16 v[24:39], v[164:167], v[4:7], v[24:39]
    s_cmp_ge_u32 s15, 14
    s_cbranch_scc1 C_nost
    s_nop 9
    v_cvt_pk_bf16_f32 v40, v24, v25
    v_cvt_pk_bf16_f32 v41, v26, v27
    v_cvt_pk_bf16_f32 v42, v28, v29
    v_cvt_pk_bf16_f32 v43, v30, v31
    v_cvt_pk_bf16_f32 v44, v32, v33
    v_cvt_pk_bf16_f32 v45, v34, v35
    v_cvt_pk_bf16_f32 v46, v36, v37
    v_cvt_pk_bf16_f32 v47, v38, v39
    v_permlane32_swap_b32 v40, v42
    v_permlane32_swap_b32 v41, v43
    v_permlane32_swap_b32 v44, v46
    v_permlane32_swap_b32 v45, v47
    buffer_store_dwordx4 v[40:43], v11, s[36:39], s22 offen nt
    buffer_store_dwordx4 v[44:47], v11, s[36:39], s22 offen offset:32 nt
C_nost:
    s_cmp_lg_u32 s2, 0
    s_cbranch_scc1 C_fin
    s_cmp_lg_u32 s4, 3
    s_cbranch_scc1 C_fin
    s_mov_b32 s11, 1024
    s_mov_b32 s47, 0
CR_poll:
    buffer_load_dwordx4 v[12:15], v3, s[48:51], s11 offen sc1
    s_add_u32 s47, s47, 1
    s_waitcnt vmcnt(0)
    v_xor_b32 v12, s46, v12
    v_xor_b32 v13, s46, v13
    v_xor_b32 v14, s46, v14
    v_xor_b32 v15, s46, v15
    v_or3_b32 v12, v12, v13, v14
    v_or_b32 v12, v12, v15
    v_cmp_ne_u32 vcc, 0, v12
    s_cbranch_vccz CR_ok
    s_cmp_lt_u32 s47, 400000
    s_sleep 4
    s_cbranch_scc1 CR_poll
CR_ok:
    s_mov_b64 exec, 1
    buffer_store_dword v1, v0, s[48:51], 0 offen sc1
    s_mov_b64 exec, -1
C_fin:
F_end:
    s_endpgm
.section .rodata,"a"
.p2align 6
.amdhsa_kernel concat_heads__ssm_conv_s4d__grouped_kv_mqa__prompt_kernel
  .amdhsa_next_free_vgpr 168
  .amdhsa_next_free_sgpr 64
  .amdhsa_accum_offset 168
  .amdhsa_group_segment_fixed_size 0
  .amdhsa_kernarg_size 120
  .amdhsa_user_sgpr_count 2
  .amdhsa_user_sgpr_kernarg_segment_ptr 1
  .amdhsa_system_sgpr_workgroup_id_x 1
.end_amdhsa_kernel
```
